```python
import torch

def _softmax(x, axis=-1):
    return torch.softmax(x, dim=axis)
def _gelu(x):
    return torch.nn.functional.gelu(x, approximate="tanh")
def _silu(x):
    return torch.nn.functional.silu(x)
def _sigmoid(x):
    return torch.sigmoid(x)
def _layernorm(x, axis=-1, eps=1e-5):
    m = x.mean(dim=axis, keepdim=True)
    v = x.var(dim=axis, keepdim=True, unbiased=False)
    return (x - m) / torch.sqrt(v + eps)
def _scatter_add(tgt, idx, src, axis=0):
    return tgt.clone().index_add_(axis, idx, src)
def _segment_sum(src, seg, n):
    out = torch.zeros((n,) + src.shape[1:], dtype=src.dtype)
    return out.index_add_(0, seg, src)
def _pad(x, pw):
    flat = tuple(v for pair in reversed(pw) for v in pair)
    return torch.nn.functional.pad(x, flat)

kernel_name = 'recurrent_scan__gqa_block_cached__glu_gated_swiglu__decode'

def setup_inputs():

    _w = (lambda a: (lambda t: t.to(torch.bfloat16) if t.is_floating_point() else t)(torch.as_tensor(a)))
    def _A_setup():
        B, Sq, D = 4, 1, 448
        Hq, Hkv, Sk, Dh = 16, 8, 4096, 256
        assert Hq % Hkv == 0, (Hq, Hkv)
        return {
            "x": _w((lambda *s: torch.randn(*s, dtype=torch.bfloat16) * 0.05)(B, Sq, D)),
            "k_cache": _w((lambda *s: torch.randn(*s, dtype=torch.bfloat16) * 3.2)(B, Hkv, Sk, Dh)),
            "v_cache": _w((lambda *s: torch.randn(*s, dtype=torch.bfloat16) * 3.2)(B, Hkv, Sk, Dh)),
            "wq": _w((lambda *s: torch.randn(*s, dtype=torch.bfloat16) * 3.2)(D, Hq * Dh) * (D ** -0.5)),
            "wo": _w((lambda *s: torch.randn(*s, dtype=torch.bfloat16) * 3.2)(Hq * Dh, D) * ((Hq * Dh) ** -0.5)),
        }
    _A_in = _A_setup()

    def _B_setup():
        B, S, D, F = 4, 1, 448, 1792
        return {
            "x": _w((lambda *s: torch.randn(*s, dtype=torch.bfloat16) * 0.05)(B, S, D)),
            "w1": _w((lambda *s: torch.randn(*s, dtype=torch.bfloat16) * 0.4)(D, F) * (2.0 / D) ** 0.5),
            "w3": _w((lambda *s: torch.randn(*s, dtype=torch.bfloat16) * 0.4)(D, F) * (2.0 / D) ** 0.5),
            "w2": _w((lambda *s: torch.randn(*s, dtype=torch.bfloat16) * 0.4)(F, D) * (2.0 / F) ** 0.5),
        }
    _B_in = _B_setup()

    return {
        "A_x": _A_in["x"],
        "A_k_cache": _A_in["k_cache"],
        "A_v_cache": _A_in["v_cache"],
        "A_wq": _A_in["wq"],
        "A_wo": _A_in["wo"],
        "B_x": _B_in["x"],
        "B_w1": _B_in["w1"],
        "B_w3": _B_in["w3"],
        "B_w2": _B_in["w2"],
    }

def reference(A_x, A_k_cache, A_v_cache, A_wq, A_wo, B_x, B_w1, B_w3, B_w2):
    def _A_ref(x, k_cache, v_cache, wq, wo):
        B, Sq, D = x.shape
        Hq, Dh = 16, 256
        Hkv = k_cache.shape[1]
        rep = Hq // Hkv
        q = (lambda x, *d: x.permute(*d))((x @ wq).reshape(B, Sq, Hq, Dh), 0, 2, 1, 3)
        k = (lambda x, n, axis: torch.repeat_interleave(x, n, dim=axis))(k_cache, rep, axis=1)
        v = (lambda x, n, axis: torch.repeat_interleave(x, n, dim=axis))(v_cache, rep, axis=1)
        scores = torch.einsum("bhqd,bhkd->bhqk", q, k) * (Dh ** -0.5)
        p = _softmax(scores, axis=-1)
        o = torch.einsum("bhqk,bhkd->bhqd", p, v)
        return (lambda x, *d: x.permute(*d))(o, 0, 2, 1, 3).reshape(B, Sq, Hq * Dh) @ wo

    def _B_ref(x, w1, w3, w2):
        gate = torch.einsum("bsd,df->bsf", x, w1)
        up = torch.einsum("bsd,df->bsf", x, w3)
        h = _silu(gate) * up
        out = torch.einsum("bsf,fd->bsd", h, w2)
        return out

    x = A_x
    xn = _layernorm(x, axis=-1)
    s = _A_ref(xn, A_k_cache, A_v_cache, A_wq, A_wo)
    g = _silu(_B_ref(xn, B_w1, B_w3, B_w2))
    return x + s * g
```

```asm
; @launch grid=(256,1,1) block=(256,1,1) lds=72704
.amdgcn_target "amdgcn-amd-amdhsa--gfx950"
.text
.globl recurrent_scan__gqa_block_cached__glu_gated_swiglu__decode_kernel
.p2align 8
.type recurrent_scan__gqa_block_cached__glu_gated_swiglu__decode_kernel,@function
recurrent_scan__gqa_block_cached__glu_gated_swiglu__decode_kernel:
    s_cmp_ge_u32 s2, 256
    s_cbranch_scc1 L_end
    s_load_dwordx16 s[16:31], s[0:1], 0
    s_load_dwordx8 s[32:39], s[0:1], 64
    v_lshrrev_b32 v1, 6, v0
    v_and_b32 v0, 63, v0
    v_readfirstlane_b32 s3, v1
    v_lshrrev_b32 v4, 4, v0
    v_and_b32 v5, 15, v0
    s_and_b32 s7, s2, 7
    s_lshr_b32 s8, s2, 3
    s_lshl_b32 s12, s7, 2
    s_lshr_b32 s12, 0x2351, s12
    s_and_b32 s12, s12, 15
    s_add_u32 s12, s12, s8
    s_and_b32 s12, s12, 31
    s_lshl_b32 s15, s7, 5
    s_add_u32 s15, s15, s12
    s_cmp_eq_u32 s3, 0
    s_cbranch_scc1 L_hx
    v_bfe_u32 v6, v0, 2, 2
    v_and_b32 v7, 3, v0
    v_lshlrev_b32 v1, 6, v4
    v_lshl_add_u32 v1, v6, 9, v1
    v_lshl_add_u32 v1, v7, 4, v1
    s_sub_u32 s13, s3, 1
    s_lshl_b32 s65, s2, 18
    s_lshl_b32 s68, s13, 11
    s_mov_b32 s46, 262144
    s_mov_b32 s47, 0x20000
    s_cmp_lt_u32 s15, 148
    s_waitcnt lgkmcnt(0)
    s_cbranch_scc1 L_tile
    s_add_u32 s44, s18, s65
    s_addc_u32 s45, s19, 0
    buffer_load_dwordx4 a[0:3], v1, s[44:47], s68 offen offset:0 nt
    buffer_load_dwordx4 a[4:7], v1, s[44:47], s68 offen offset:256 nt
    s_add_u32 s68, s68, 6144
    buffer_load_dwordx4 a[8:11], v1, s[44:47], s68 offen offset:0 nt
    buffer_load_dwordx4 a[12:15], v1, s[44:47], s68 offen offset:256 nt
    s_add_u32 s68, s68, 6144
    buffer_load_dwordx4 a[16:19], v1, s[44:47], s68 offen offset:0 nt
    buffer_load_dwordx4 a[20:23], v1, s[44:47], s68 offen offset:256 nt
    s_add_u32 s68, s68, 6144
    buffer_load_dwordx4 a[24:27], v1, s[44:47], s68 offen offset:0 nt
    buffer_load_dwordx4 a[28:31], v1, s[44:47], s68 offen offset:256 nt
    s_add_u32 s68, s68, 6144
    buffer_load_dwordx4 a[32:35], v1, s[44:47], s68 offen offset:0 nt
    buffer_load_dwordx4 a[36:39], v1, s[44:47], s68 offen offset:256 nt
    s_add_u32 s68, s68, 6144
    buffer_load_dwordx4 a[40:43], v1, s[44:47], s68 offen offset:0 nt
    s_branch L_notile
L_hx:
    v_mul_u32_u24 v2, 896, v4
    v_lshlrev_b32 v6, 6, v5
    v_add_u32 v2, v2, v6
    v_mov_b32 v7, 0x40000000
    v_cmp_lt_u32 s[80:81], 13, v5
    s_nop 1
    v_cndmask_b32 v2, v2, v7, s[80:81]
    s_mov_b32 s46, 3584
    s_mov_b32 s47, 0x20000
    s_cmp_lt_u32 s15, 120
    s_waitcnt lgkmcnt(0)
    s_mov_b32 s44, s16
    s_mov_b32 s45, s17
    s_cbranch_scc0 L_hx2
    buffer_load_dwordx4 v[16:19], v2, s[44:47], 0 offen offset:0
    buffer_load_dwordx4 v[20:23], v2, s[44:47], 0 offen offset:16
    buffer_load_dwordx4 v[24:27], v2, s[44:47], 0 offen offset:32
    buffer_load_dwordx4 v[28:31], v2, s[44:47], 0 offen offset:48
L_hx2:
    s_mov_b32 s40, s38
    s_mov_b32 s41, s39
    s_mov_b32 s42, 4194304
    s_mov_b32 s43, 0x20000
    v_lshlrev_b32 v1, 4, v0
    v_mov_b32 v48, -1
    v_mov_b32 v49, -1
    v_mov_b32 v50, -1
    v_mov_b32 v51, -1
    s_lshl_b32 s72, s2, 11
    s_add_u32 s71, s72, 1048576
    s_add_u32 s72, s72, 1572864
    buffer_store_dwordx4 v[48:51], v1, s[40:43], s71 offen offset:0 sc1
    buffer_store_dwordx4 v[48:51], v1, s[40:43], s71 offen offset:1024 sc1
    buffer_store_dwordx4 v[48:51], v1, s[40:43], s72 offen offset:0 sc1
    buffer_store_dwordx4 v[48:51], v1, s[40:43], s72 offen offset:1024 sc1
    s_branch L_helper
L_tile:
    s_cmp_lt_u32 s15, 64
    s_cselect_b32 s52, s22, s28
    s_cselect_b32 s53, s23, s29
    s_mov_b32 s54, 1605632
    s_cselect_b32 s54, 3670016, s54
    s_mov_b32 s71, 3584
    s_cselect_b32 s71, 8192, s71
    s_cselect_b32 s14, 0, 64
    s_cmp_ge_u32 s15, 92
    s_cselect_b32 s52, s30, s52
    s_cselect_b32 s53, s31, s53
    s_cselect_b32 s14, 92, s14
    s_mov_b32 s67, 128
    s_cmp_ge_u32 s15, 120
    s_cselect_b32 s52, s32, s52
    s_cselect_b32 s53, s33, s53
    s_cselect_b32 s14, 120, s14
    s_cselect_b32 s71, 128, s71
    s_cselect_b32 s67, 57344, s67
    s_mov_b32 s55, 0x20000
    v_lshrrev_b32 v6, 3, v0
    v_mul_lo_u32 v6, v6, s71
    v_and_b32 v7, 7, v0
    v_lshl_add_u32 v6, v7, 4, v6
    s_sub_u32 s14, s15, s14
    s_lshl_b32 s12, s13, 3
    s_mul_i32 s12, s12, s71
    s_mul_i32 s66, s14, s67
    s_add_u32 s12, s12, s66
    s_mul_i32 s66, s71, 24
    s_lshl_b32 s67, s13, 10
    s_add_u32 m0, s67, 8192
    s_nop 0
    buffer_load_dwordx4 v6, s[52:55], s12 offen lds
    s_add_u32 m0, s67, 11264
    s_add_u32 s12, s12, s66
    buffer_load_dwordx4 v6, s[52:55], s12 offen lds
    s_add_u32 m0, s67, 14336
    s_add_u32 s12, s12, s66
    buffer_load_dwordx4 v6, s[52:55], s12 offen lds
    s_add_u32 m0, s67, 17408
    s_add_u32 s12, s12, s66
    buffer_load_dwordx4 v6, s[52:55], s12 offen lds
    s_add_u32 m0, s67, 20480
    s_add_u32 s12, s12, s66
    buffer_load_dwordx4 v6, s[52:55], s12 offen lds
    s_add_u32 m0, s67, 23552
    s_add_u32 s12, s12, s66
    buffer_load_dwordx4 v6, s[52:55], s12 offen lds
    s_add_u32 m0, s67, 26624
    s_add_u32 s12, s12, s66
    buffer_load_dwordx4 v6, s[52:55], s12 offen lds
    s_add_u32 m0, s67, 29696
    s_add_u32 s12, s12, s66
    buffer_load_dwordx4 v6, s[52:55], s12 offen lds
    s_add_u32 m0, s67, 32768
    s_add_u32 s12, s12, s66
    buffer_load_dwordx4 v6, s[52:55], s12 offen lds
    s_add_u32 m0, s67, 35840
    s_add_u32 s12, s12, s66
    buffer_load_dwordx4 v6, s[52:55], s12 offen lds
    s_add_u32 m0, s67, 38912
    s_add_u32 s12, s12, s66
    buffer_load_dwordx4 v6, s[52:55], s12 offen lds
    s_add_u32 m0, s67, 41984
    s_add_u32 s12, s12, s66
    buffer_load_dwordx4 v6, s[52:55], s12 offen lds
    s_add_u32 m0, s67, 45056
    s_add_u32 s12, s12, s66
    buffer_load_dwordx4 v6, s[52:55], s12 offen lds
    s_add_u32 m0, s67, 48128
    s_add_u32 s12, s12, s66
    buffer_load_dwordx4 v6, s[52:55], s12 offen lds
    s_add_u32 m0, s67, 51200
    s_add_u32 s12, s12, s66
    buffer_load_dwordx4 v6, s[52:55], s12 offen lds
    s_add_u32 m0, s67, 54272
    s_add_u32 s12, s12, s66
    buffer_load_dwordx4 v6, s[52:55], s12 offen lds
    s_add_u32 m0, s67, 57344
    s_add_u32 s12, s12, s66
    buffer_load_dwordx4 v6, s[52:55], s12 offen lds
    s_add_u32 m0, s67, 60416
    s_add_u32 s12, s12, s66
    buffer_load_dwordx4 v6, s[52:55], s12 offen lds
    s_add_u32 m0, s67, 63488
    s_add_u32 s12, s12, s66
    buffer_load_dwordx4 v6, s[52:55], s12 offen lds
    s_add_u32 s44, s18, s65
    s_addc_u32 s45, s19, 0
    buffer_load_dwordx4 a[0:3], v1, s[44:47], s68 offen offset:0 nt
    buffer_load_dwordx4 a[4:7], v1, s[44:47], s68 offen offset:256 nt
    s_add_u32 s68, s68, 6144
    buffer_load_dwordx4 a[8:11], v1, s[44:47], s68 offen offset:0 nt
    buffer_load_dwordx4 a[12:15], v1, s[44:47], s68 offen offset:256 nt
    s_add_u32 s68, s68, 6144
    s_cmp_lt_u32 s15, 120
    s_cbranch_scc1 L_notile
    buffer_load_dwordx4 a[16:19], v1, s[44:47], s68 offen offset:0 nt
    buffer_load_dwordx4 a[20:23], v1, s[44:47], s68 offen offset:256 nt
    s_add_u32 s68, s68, 6144
    buffer_load_dwordx4 a[24:27], v1, s[44:47], s68 offen offset:0 nt
    buffer_load_dwordx4 a[28:31], v1, s[44:47], s68 offen offset:256 nt
    s_add_u32 s68, s68, 6144
    buffer_load_dwordx4 a[32:35], v1, s[44:47], s68 offen offset:0 nt
    buffer_load_dwordx4 a[36:39], v1, s[44:47], s68 offen offset:256 nt
    s_add_u32 s68, s68, 6144
    buffer_load_dwordx4 a[40:43], v1, s[44:47], s68 offen offset:0 nt
L_notile:
    s_lshr_b32 s6, s8, 3
    s_and_b32 s4, s8, 7
    s_lshl_b32 s9, s4, 3
    s_add_u32 s9, s9, s7
    s_mov_b32 s5, 0
    s_mov_b64 s[0:1], -1
    s_mov_b32 s40, s38
    s_mov_b32 s41, s39
    s_mov_b32 s42, 4194304
    s_mov_b32 s43, 0x20000
    s_lshl_b32 s63, s8, 21
    s_add_u32 s48, s20, s63
    s_addc_u32 s49, s21, 0
    s_mov_b32 s50, 2097152
    s_mov_b32 s51, 0x20000
    s_lshl_b32 s69, s7, 18
    s_lshl_b32 s12, s13, 11
    s_add_u32 s69, s69, s12
    s_add_u32 s69, s69, 98304
    s_lshr_b32 s64, s13, 1
    s_mul_i32 s59, s13, 6144
    s_sub_u32 s59, 18432, s59
    v_lshlrev_b32 v2, 9, v4
    v_lshlrev_b32 v6, 4, v5
    v_add_u32 v2, v2, v6
    v_mul_u32_u24 v3, 7168, v4
    v_and_b32 v6, 7, v0
    v_lshlrev_b32 v6, 4, v6
    v_add_u32 v3, v3, v6
    v_bfe_u32 v6, v0, 3, 1
    v_mul_u32_u24 v6, 229376, v6
    v_add_u32 v3, v3, v6
    s_lshl_b32 s70, s4, 9
    s_lshl_b32 s12, s7, 5
    s_add_u32 s70, s70, s12
    s_mul_i32 s70, s70, 896
    s_lshl_b32 s12, s13, 8
    s_add_u32 s70, s70, s12
    v_and_b32 v6, 1, v0
    v_mov_b32 v7, 0xffff
    v_mov_b32 v8, 0xffff0000
    v_cmp_eq_u32 vcc, 1, v6
    s_nop 1
    v_cndmask_b32 v7, v7, v8, vcc
    v_bfe_u32 v6, v0, 1, 2
    v_cmp_eq_u32 vcc, 0, v6
    s_nop 1
    v_cndmask_b32 v16, 0, v7, vcc
    v_cmp_eq_u32 vcc, 1, v6
    s_nop 1
    v_cndmask_b32 v17, 0, v7, vcc
    v_cmp_eq_u32 vcc, 2, v6
    s_nop 1
    v_cndmask_b32 v18, 0, v7, vcc
    v_cmp_eq_u32 vcc, 3, v6
    s_nop 1
    v_cndmask_b32 v19, 0, v7, vcc
    v_mov_b32 v20, 0
    v_mov_b32 v21, 0
    v_mov_b32 v22, 0
    v_mov_b32 v23, 0
    v_mov_b32 v24, 0
    v_mov_b32 v25, 0
    v_mov_b32 v26, 0
    v_mov_b32 v27, 0
    s_cmp_lt_u32 s15, 120
    s_cbranch_scc0 L_noproj
    s_mov_b32 s74, 0xffff0000
    s_mov_b32 s75, 0
    s_mov_b32 s76, 0
    s_mov_b32 s77, 0xffff
    s_mov_b32 s78, 0
    s_mov_b32 s79, 0xffff0000
    v_and_b32 v8, 3, v0
    v_lshlrev_b32 v9, 10, v8
    v_lshlrev_b32 v10, 4, v4
    v_add_u32 v9, v9, v10
    v_bfe_u32 v10, v0, 2, 2
    v_lshlrev_b32 v11, 3, v4
    v_add_u32 v10, v10, v11
    v_lshlrev_b32 v10, 7, v10
    v_lshlrev_b32 v11, 3, v8
    v_add_u32 v10, v10, v11
    s_lshl_b32 s12, s13, 5
    v_add_u32 v10, s12, v10
    v_mov_b32 v12, 5120
    v_mul_u32_u24 v11, 30720, v4
    v_lshlrev_b32 v13, 2, v5
    v_add_u32 v11, v11, v13
    s_lshl_b32 s72, s15, 6
    s_lshl_b32 s12, s13, 4
    s_add_u32 s72, s72, s12
    s_lshl_b32 s72, s72, 2
    s_add_u32 s72, s72, 4096
    s_waitcnt vmcnt(4)
    buffer_load_dwordx4 a[16:19], v1, s[44:47], s68 offen offset:0 nt
    buffer_load_dwordx4 a[20:23], v1, s[44:47], s68 offen offset:256 nt
    s_add_u32 s68, s68, 6144
    buffer_load_dwordx4 a[24:27], v1, s[44:47], s68 offen offset:0 nt
    buffer_load_dwordx4 a[28:31], v1, s[44:47], s68 offen offset:256 nt
    s_add_u32 s68, s68, 6144
    buffer_load_dwordx4 a[32:35], v1, s[44:47], s68 offen offset:0 nt
    buffer_load_dwordx4 a[36:39], v1, s[44:47], s68 offen offset:256 nt
    s_add_u32 s68, s68, 6144
    buffer_load_dwordx4 a[40:43], v1, s[44:47], s68 offen offset:0 nt
    s_barrier
    ds_read_b128 v[100:103], v9 offset:0
    ds_read_b128 v[104:107], v9 offset:64
    ds_read_b128 v[108:111], v9 offset:128
    ds_read_b128 v[112:115], v9 offset:192
    ds_read_b128 v[116:119], v9 offset:256
    ds_read_b128 v[120:123], v9 offset:320
    ds_read_b128 v[124:127], v9 offset:384
    ds_read_b128 v[128:131], v9 offset:448
    ds_read_b128 v[132:135], v9 offset:512
    ds_read_b128 v[136:139], v9 offset:576
    ds_read_b128 v[140:143], v9 offset:640
    ds_read_b128 v[144:147], v9 offset:704
    ds_read_b128 v[148:151], v9 offset:768
    ds_read_b128 v[152:155], v9 offset:832
    ds_read_b32 v13, v12
    s_waitcnt vmcnt(10)
    buffer_load_dwordx4 a[44:47], v1, s[44:47], s68 offen offset:256 nt
    s_add_u32 s68, s68, 6144
    s_waitcnt lgkmcnt(1)
    ds_read_b64_tr_b16 v[156:157], v10 offset:8192
    ds_read_b64_tr_b16 v[158:159], v10 offset:8704
    ds_read_b64_tr_b16 v[160:161], v10 offset:12288
    ds_read_b64_tr_b16 v[162:163], v10 offset:12800
    ds_read_b64_tr_b16 v[164:165], v10 offset:16384
    ds_read_b64_tr_b16 v[166:167], v10 offset:16896
    ds_read_b64_tr_b16 v[168:169], v10 offset:20480
    ds_read_b64_tr_b16 v[170:171], v10 offset:20992
    ds_read_b64_tr_b16 v[172:173], v10 offset:24576
    ds_read_b64_tr_b16 v[174:175], v10 offset:25088
    ds_read_b64_tr_b16 v[176:177], v10 offset:28672
    ds_read_b64_tr_b16 v[178:179], v10 offset:29184
    ds_read_b64_tr_b16 v[180:181], v10 offset:32768
    ds_read_b64_tr_b16 v[182:183], v10 offset:33280
    s_waitcnt vmcnt(10)
    buffer_load_dwordx4 a[48:51], v1, s[44:47], s68 offen offset:0 nt
    s_waitcnt lgkmcnt(1)
    ds_read_b64_tr_b16 v[184:185], v10 offset:36864
    ds_read_b64_tr_b16 v[186:187], v10 offset:37376
    ds_read_b64_tr_b16 v[188:189], v10 offset:40960
    ds_read_b64_tr_b16 v[190:191], v10 offset:41472
    ds_read_b64_tr_b16 v[192:193], v10 offset:45056
    ds_read_b64_tr_b16 v[194:195], v10 offset:45568
    ds_read_b64_tr_b16 v[196:197], v10 offset:49152
    ds_read_b64_tr_b16 v[198:199], v10 offset:49664
    ds_read_b64_tr_b16 v[200:201], v10 offset:53248
    ds_read_b64_tr_b16 v[202:203], v10 offset:53760
    ds_read_b64_tr_b16 v[204:205], v10 offset:57344
    ds_read_b64_tr_b16 v[206:207], v10 offset:57856
    ds_read_b64_tr_b16 v[208:209], v10 offset:61440
    ds_read_b64_tr_b16 v[210:211], v10 offset:61952
    s_waitcnt vmcnt(10)
    buffer_load_dwordx4 a[52:55], v1, s[44:47], s68 offen offset:256 nt
    s_add_u32 s68, s68, 6144
    s_waitcnt lgkmcnt(14)
    v_mfma_f32_16x16x32_bf16 v[28:31], v[100:103], v[156:159], 0
    v_mfma_f32_16x16x32_bf16 v[32:35], v[104:107], v[160:163], 0
    v_mfma_f32_16x16x32_bf16 v[28:31], v[108:111], v[164:167], v[28:31]
    v_mfma_f32_16x16x32_bf16 v[32:35], v[112:115], v[168:171], v[32:35]
    v_mfma_f32_16x16x32_bf16 v[28:31], v[116:119], v[172:175], v[28:31]
    v_mfma_f32_16x16x32_bf16 v[32:35], v[120:123], v[176:179], v[32:35]
    v_mfma_f32_16x16x32_bf16 v[28:31], v[124:127], v[180:183], v[28:31]
    s_waitcnt vmcnt(10)
    buffer_load_dwordx4 a[56:59], v1, s[44:47], s68 offen offset:0 nt
    s_waitcnt lgkmcnt(0)
    v_mfma_f32_16x16x32_bf16 v[32:35], v[128:131], v[184:187], v[32:35]
    v_mfma_f32_16x16x32_bf16 v[28:31], v[132:135], v[188:191], v[28:31]
    v_mfma_f32_16x16x32_bf16 v[32:35], v[136:139], v[192:195], v[32:35]
    v_mfma_f32_16x16x32_bf16 v[28:31], v[140:143], v[196:199], v[28:31]
    v_mfma_f32_16x16x32_bf16 v[32:35], v[144:147], v[200:203], v[32:35]
    v_mfma_f32_16x16x32_bf16 v[28:31], v[148:151], v[204:207], v[28:31]
    v_mfma_f32_16x16x32_bf16 v[32:35], v[152:155], v[208:211], v[32:35]
    s_nop 7
    v_add_f32 v28, v28, v32
    v_add_f32 v29, v29, v33
    v_add_f32 v30, v30, v34
    v_add_f32 v31, v31, v35
    v_cndmask_b32 v32, v28, v29, s[74:75]
    v_cndmask_b32 v32, v32, v30, s[76:77]
    v_cndmask_b32 v32, v32, v31, s[78:79]
    s_nop 1
    v_mov_b32_dpp v33, v32 quad_perm:[1,0,3,2] row_mask:0xf bank_mask:0xf
    v_cvt_pk_bf16_f32 v12, v32, v33
    s_mov_b32 exec_lo, 0x55555555
    s_mov_b32 exec_hi, 0x55555555
    buffer_store_dwordx2 v[12:13], v11, s[40:43], s72 offen sc1
    s_mov_b64 exec, -1
    s_branch L_projdone
L_noproj:
    s_waitcnt vmcnt(10)
    buffer_load_dwordx4 a[44:47], v1, s[44:47], s68 offen offset:256 nt
    s_add_u32 s68, s68, 6144
    s_waitcnt vmcnt(10)
    buffer_load_dwordx4 a[48:51], v1, s[44:47], s68 offen offset:0 nt
    s_waitcnt vmcnt(10)
    buffer_load_dwordx4 a[52:55], v1, s[44:47], s68 offen offset:256 nt
    s_add_u32 s68, s68, 6144
    s_waitcnt vmcnt(10)
    buffer_load_dwordx4 a[56:59], v1, s[44:47], s68 offen offset:0 nt
L_projdone:
    s_mov_b32 s52, s24
    s_mov_b32 s53, s25
    s_mov_b32 s54, 3670016
    s_mov_b32 s55, 0x20000
    v_bfe_u32 v6, v0, 3, 1
    v_lshlrev_b32 v6, 9, v6
    v_lshlrev_b32 v7, 6, v4
    v_add_u32 v6, v6, v7
    v_and_b32 v7, 3, v0
    v_lshlrev_b32 v7, 4, v7
    v_add_u32 v6, v6, v7
    v_mov_b32 v7, 5120
    v_mov_b32 v8, 1
    s_waitcnt vmcnt(10)
    buffer_load_dwordx4 a[60:63], v1, s[44:47], s68 offen offset:256 nt
    s_add_u32 s68, s68, 6144
    s_waitcnt vmcnt(10)
    buffer_load_dwordx4 a[64:67], v1, s[44:47], s68 offen offset:0 nt
    s_waitcnt vmcnt(10)
    buffer_load_dwordx4 a[68:71], v1, s[44:47], s68 offen offset:256 nt
    s_add_u32 s68, s68, 6144
    s_waitcnt vmcnt(10)
    buffer_load_dwordx4 a[72:75], v1, s[44:47], s68 offen offset:0 nt
    s_waitcnt vmcnt(10)
    buffer_load_dwordx4 a[76:79], v1, s[44:47], s68 offen offset:256 nt
    s_add_u32 s68, s68, 6144
    s_waitcnt vmcnt(10)
    buffer_load_dwordx4 a[80:83], v1, s[44:47], s68 offen offset:0 nt
    s_waitcnt vmcnt(10)
    buffer_load_dwordx4 a[84:87], v1, s[44:47], s68 offen offset:256 nt
    s_add_u32 s68, s68, 6144
    s_waitcnt vmcnt(10)
    buffer_load_dwordx4 a[88:91], v1, s[44:47], s68 offen offset:0 nt
    s_waitcnt vmcnt(10)
    buffer_load_dwordx4 a[92:95], v1, s[44:47], s68 offen offset:256 nt
    s_add_u32 s68, s68, 6144
    s_waitcnt vmcnt(10)
    buffer_load_dwordx4 a[96:99], v1, s[44:47], s68 offen offset:0 nt
    s_waitcnt vmcnt(10)
    buffer_load_dwordx4 a[100:103], v1, s[44:47], s68 offen offset:256 nt
    s_add_u32 s68, s68, 6144
    s_waitcnt vmcnt(10)
    buffer_load_dwordx4 a[104:107], v1, s[44:47], s68 offen offset:0 nt
    s_waitcnt vmcnt(10)
    buffer_load_dwordx4 a[108:111], v1, s[44:47], s68 offen offset:256 nt
    s_add_u32 s68, s68, 6144
    s_cmp_lt_u32 s15, 120
    s_cbranch_scc1 L_nob0
    s_barrier
L_nob0:
    s_waitcnt vmcnt(10)
    buffer_load_dwordx4 a[112:115], v1, s[44:47], s68 offen offset:0 nt
    s_waitcnt vmcnt(10)
    buffer_load_dwordx4 a[116:119], v1, s[44:47], s68 offen offset:256 nt
    s_add_u32 s68, s68, 6144
    s_waitcnt vmcnt(10)
    buffer_load_dwordx4 a[120:123], v1, s[44:47], s68 offen offset:0 nt
    s_waitcnt vmcnt(10)
    buffer_load_dwordx4 a[124:127], v1, s[44:47], s68 offen offset:256 nt
    s_add_u32 s68, s68, 6144
    s_cmp_gt_u32 s64, 0
    s_cbranch_scc1 L_skip1
    s_waitcnt vmcnt(10)
    buffer_load_dwordx4 a[128:131], v1, s[44:47], s68 offen offset:0 nt
L_skip1:
    s_cmp_gt_u32 s64, 0
    s_cbranch_scc1 L_skip2
    s_waitcnt vmcnt(10)
    buffer_load_dwordx4 a[132:135], v1, s[44:47], s68 offen offset:256 nt
    s_add_u32 s68, s68, 6144
L_skip2:
    s_waitcnt vmcnt(10)
    buffer_load_dwordx4 a[136:139], v1, s[44:47], s68 offen offset:0 nt
    s_waitcnt vmcnt(10)
    buffer_load_dwordx4 a[140:143], v1, s[44:47], s68 offen offset:256 nt
    s_add_u32 s68, s68, 6144
    s_waitcnt vmcnt(10)
    buffer_load_dwordx4 a[144:147], v1, s[44:47], s68 offen offset:0 nt
    s_waitcnt vmcnt(10)
    buffer_load_dwordx4 a[148:151], v1, s[44:47], s68 offen offset:256 nt
    s_add_u32 s68, s68, 6144
    s_waitcnt vmcnt(10)
    buffer_load_dwordx4 a[152:155], v1, s[44:47], s68 offen offset:0 nt
    s_waitcnt vmcnt(10)
    buffer_load_dwordx4 a[156:159], v1, s[44:47], s68 offen offset:256 nt
    s_add_u32 s68, s68, 6144
    s_waitcnt vmcnt(10)
    buffer_load_dwordx4 a[160:163], v1, s[44:47], s68 offen offset:0 nt
    s_waitcnt vmcnt(10)
    buffer_load_dwordx4 a[164:167], v1, s[44:47], s68 offen offset:256 nt
    s_add_u32 s68, s68, 6144
    ds_write_b32 v7, v8 offset:8
    s_waitcnt vmcnt(10)
    buffer_load_dwordx4 a[168:171], v1, s[44:47], s68 offen offset:0 nt
    s_waitcnt vmcnt(10)
    buffer_load_dwordx4 a[172:175], v1, s[44:47], s68 offen offset:256 nt
    s_add_u32 s68, s68, 6144
    s_waitcnt vmcnt(10)
    buffer_load_dwordx4 a[176:179], v1, s[44:47], s68 offen offset:0 nt
    s_waitcnt vmcnt(10)
    buffer_load_dwordx4 a[180:183], v1, s[44:47], s68 offen offset:256 nt
    s_add_u32 s68, s68, 6144
    s_waitcnt vmcnt(10)
    buffer_load_dwordx4 a[184:187], v1, s[44:47], s68 offen offset:0 nt
    s_waitcnt vmcnt(10)
    buffer_load_dwordx4 a[188:191], v1, s[44:47], s68 offen offset:256 nt
    s_add_u32 s68, s68, 6144
    s_waitcnt vmcnt(10)
    buffer_load_dwordx4 a[192:195], v1, s[44:47], s68 offen offset:0 nt
    s_waitcnt vmcnt(10)
    buffer_load_dwordx4 a[196:199], v1, s[44:47], s68 offen offset:256 nt
    s_add_u32 s68, s68, 6144
    s_waitcnt vmcnt(10)
    buffer_load_dwordx4 a[200:203], v1, s[44:47], s68 offen offset:0 nt
    s_waitcnt vmcnt(10)
    buffer_load_dwordx4 a[204:207], v1, s[44:47], s68 offen offset:256 nt
    s_add_u32 s68, s68, 6144
    s_waitcnt vmcnt(10)
    buffer_load_dwordx4 a[208:211], v1, s[44:47], s68 offen offset:0 nt
    s_waitcnt vmcnt(10)
    buffer_load_dwordx4 a[212:215], v1, s[44:47], s68 offen offset:256 nt
    s_add_u32 s68, s68, 6144
    s_waitcnt vmcnt(10)
    buffer_load_dwordx4 a[216:219], v1, s[44:47], s68 offen offset:0 nt
    s_waitcnt vmcnt(10)
    buffer_load_dwordx4 a[220:223], v1, s[44:47], s68 offen offset:256 nt
    s_add_u32 s68, s68, 6144
    s_waitcnt vmcnt(10)
    buffer_load_dwordx4 a[224:227], v1, s[44:47], s68 offen offset:0 nt
    s_waitcnt vmcnt(10)
    buffer_load_dwordx4 a[228:231], v1, s[44:47], s68 offen offset:256 nt
    s_add_u32 s68, s68, 6144
    s_waitcnt vmcnt(10)
    buffer_load_dwordx4 a[232:235], v1, s[44:47], s68 offen offset:0 nt
    s_waitcnt vmcnt(10)
    buffer_load_dwordx4 a[236:239], v1, s[44:47], s68 offen offset:256 nt
    s_add_u32 s68, s68, 6144
    s_waitcnt vmcnt(10)
    buffer_load_dwordx4 a[240:243], v1, s[44:47], s68 offen offset:0 nt
    s_waitcnt vmcnt(10)
    buffer_load_dwordx4 a[244:247], v1, s[44:47], s68 offen offset:256 nt
    s_add_u32 s68, s68, 6144
    s_waitcnt vmcnt(10)
    buffer_load_dwordx4 a[248:251], v1, s[44:47], s68 offen offset:0 nt
    s_waitcnt vmcnt(10)
    buffer_load_dwordx4 a[252:255], v1, s[44:47], s68 offen offset:256 nt
    s_add_u32 s68, s68, 6144
    s_waitcnt vmcnt(10)
    buffer_load_dwordx4 v[240:243], v1, s[44:47], s68 offen offset:0 nt
    s_waitcnt vmcnt(10)
    buffer_load_dwordx4 v[236:239], v1, s[44:47], s68 offen offset:256 nt
    s_add_u32 s68, s68, 6144
    s_waitcnt vmcnt(10)
    buffer_load_dwordx4 v[232:235], v1, s[44:47], s68 offen offset:0 nt
    s_waitcnt vmcnt(10)
    buffer_load_dwordx4 v[228:231], v1, s[44:47], s68 offen offset:256 nt
    s_add_u32 s68, s68, 6144
    s_waitcnt vmcnt(10)
    buffer_load_dwordx4 v[224:227], v1, s[44:47], s68 offen offset:0 nt
    s_waitcnt vmcnt(10)
    buffer_load_dwordx4 v[220:223], v1, s[44:47], s68 offen offset:256 nt
    s_add_u32 s68, s68, 6144
    s_waitcnt vmcnt(10)
    buffer_load_dwordx4 v[216:219], v1, s[44:47], s68 offen offset:0 nt
    s_waitcnt vmcnt(10)
    buffer_load_dwordx4 v[212:215], v1, s[44:47], s68 offen offset:256 nt
    s_add_u32 s68, s68, 6144
L_qwait:
    ds_read_b32 v96, v7 offset:4
    s_waitcnt lgkmcnt(0)
    v_cmp_eq_u32 vcc, 0, v96
    s_nop 1
    s_cbranch_vccz L_qwait_ok
    s_sleep 1
    s_branch L_qwait
L_qwait_ok:
    v_mov_b32 v96, 0xff800000
    v_mov_b32 v94, 0xff800000
    v_mov_b32 v87, 0xff800000
    ds_read_b128 v[8:11], v6 offset:4096
    ds_read_b128 v[12:15], v6 offset:4352
    ds_read_b32 v97, v7
    ds_read_b32 v95, v7 offset:16
    s_waitcnt lgkmcnt(0)
    v_readfirstlane_b32 s62, v95
    v_mfma_f32_16x16x32_bf16 v[28:31], a[0:3], v[8:11], 0
    v_mfma_f32_16x16x32_bf16 v[28:31], a[4:7], v[12:15], v[28:31]
    v_mfma_f32_16x16x32_bf16 v[32:35], a[8:11], v[8:11], 0
    v_mfma_f32_16x16x32_bf16 v[32:35], a[12:15], v[12:15], v[32:35]
    s_nop 5
    v_mov_b32_dpp v4, v28 quad_perm:[0,0,0,0] row_mask:0xf bank_mask:0xf
    v_mov_b32_dpp v5, v30 quad_perm:[2,2,2,2] row_mask:0xf bank_mask:0xf
    s_nop 0
    v_add_f32_dpp v4, v29, v4 quad_perm:[1,1,1,1] row_mask:0xf bank_mask:0xf
    v_add_f32_dpp v5, v31, v5 quad_perm:[3,3,3,3] row_mask:0xf bank_mask:0xf
    v_add_f32 v44, v4, v5
    s_waitcnt vmcnt(10)
    buffer_load_dwordx4 v[208:211], v1, s[44:47], s68 offen offset:0 nt
    v_mfma_f32_16x16x32_bf16 v[28:31], a[16:19], v[8:11], 0
    v_mfma_f32_16x16x32_bf16 v[28:31], a[20:23], v[12:15], v[28:31]
    v_mov_b32_dpp v4, v32 quad_perm:[0,0,0,0] row_mask:0xf bank_mask:0xf
    v_mov_b32_dpp v5, v34 quad_perm:[2,2,2,2] row_mask:0xf bank_mask:0xf
    s_nop 0
    v_add_f32_dpp v4, v33, v4 quad_perm:[1,1,1,1] row_mask:0xf bank_mask:0xf
    v_add_f32_dpp v5, v35, v5 quad_perm:[3,3,3,3] row_mask:0xf bank_mask:0xf
    v_add_f32 v45, v4, v5
    v_max3_f32 v96, v96, v44, v45
    v_mfma_f32_16x16x32_bf16 v[32:35], a[24:27], v[8:11], 0
    v_mfma_f32_16x16x32_bf16 v[32:35], a[28:31], v[12:15], v[32:35]
    v_mov_b32_dpp v4, v28 quad_perm:[0,0,0,0] row_mask:0xf bank_mask:0xf
    v_mov_b32_dpp v5, v30 quad_perm:[2,2,2,2] row_mask:0xf bank_mask:0xf
    s_nop 0
    v_add_f32_dpp v4, v29, v4 quad_perm:[1,1,1,1] row_mask:0xf bank_mask:0xf
    v_add_f32_dpp v5, v31, v5 quad_perm:[3,3,3,3] row_mask:0xf bank_mask:0xf
    v_add_f32 v46, v4, v5
    s_waitcnt vmcnt(10)
    buffer_load_dwordx4 v[204:207], v1, s[44:47], s68 offen offset:256 nt
    s_add_u32 s68, s68, 6144
    v_mfma_f32_16x16x32_bf16 v[28:31], a[32:35], v[8:11], 0
    v_mfma_f32_16x16x32_bf16 v[28:31], a[36:39], v[12:15], v[28:31]
    v_mov_b32_dpp v4, v32 quad_perm:[0,0,0,0] row_mask:0xf bank_mask:0xf
    v_mov_b32_dpp v5, v34 quad_perm:[2,2,2,2] row_mask:0xf bank_mask:0xf
    s_nop 0
    v_add_f32_dpp v4, v33, v4 quad_perm:[1,1,1,1] row_mask:0xf bank_mask:0xf
    v_add_f32_dpp v5, v35, v5 quad_perm:[3,3,3,3] row_mask:0xf bank_mask:0xf
    v_add_f32 v47, v4, v5
    v_max3_f32 v96, v96, v46, v47
    v_mfma_f32_16x16x32_bf16 v[32:35], a[40:43], v[8:11], 0
    v_mfma_f32_16x16x32_bf16 v[32:35], a[44:47], v[12:15], v[32:35]
    v_mov_b32_dpp v4, v28 quad_perm:[0,0,0,0] row_mask:0xf bank_mask:0xf
    v_mov_b32_dpp v5, v30 quad_perm:[2,2,2,2] row_mask:0xf bank_mask:0xf
    s_nop 0
    v_add_f32_dpp v4, v29, v4 quad_perm:[1,1,1,1] row_mask:0xf bank_mask:0xf
    v_add_f32_dpp v5, v31, v5 quad_perm:[3,3,3,3] row_mask:0xf bank_mask:0xf
    v_add_f32 v48, v4, v5
    s_waitcnt vmcnt(10)
    buffer_load_dwordx4 v[200:203], v1, s[44:47], s68 offen offset:0 nt
    v_mfma_f32_16x16x32_bf16 v[28:31], a[48:51], v[8:11], 0
    v_mfma_f32_16x16x32_bf16 v[28:31], a[52:55], v[12:15], v[28:31]
    v_mov_b32_dpp v4, v32 quad_perm:[0,0,0,0] row_mask:0xf bank_mask:0xf
    v_mov_b32_dpp v5, v34 quad_perm:[2,2,2,2] row_mask:0xf bank_mask:0xf
    s_nop 0
    v_add_f32_dpp v4, v33, v4 quad_perm:[1,1,1,1] row_mask:0xf bank_mask:0xf
    v_add_f32_dpp v5, v35, v5 quad_perm:[3,3,3,3] row_mask:0xf bank_mask:0xf
    v_add_f32 v49, v4, v5
    v_max3_f32 v96, v96, v48, v49
    v_mfma_f32_16x16x32_bf16 v[32:35], a[56:59], v[8:11], 0
    v_mfma_f32_16x16x32_bf16 v[32:35], a[60:63], v[12:15], v[32:35]
    v_mov_b32_dpp v4, v28 quad_perm:[0,0,0,0] row_mask:0xf bank_mask:0xf
    v_mov_b32_dpp v5, v30 quad_perm:[2,2,2,2] row_mask:0xf bank_mask:0xf
    s_nop 0
    v_add_f32_dpp v4, v29, v4 quad_perm:[1,1,1,1] row_mask:0xf bank_mask:0xf
    v_add_f32_dpp v5, v31, v5 quad_perm:[3,3,3,3] row_mask:0xf bank_mask:0xf
    v_add_f32 v50, v4, v5
    s_waitcnt vmcnt(10)
    buffer_load_dwordx4 v[196:199], v1, s[44:47], s68 offen offset:256 nt
    s_add_u32 s68, s68, 6144
    v_mfma_f32_16x16x32_bf16 v[28:31], a[64:67], v[8:11], 0
    v_mfma_f32_16x16x32_bf16 v[28:31], a[68:71], v[12:15], v[28:31]
    v_mov_b32_dpp v4, v32 quad_perm:[0,0,0,0] row_mask:0xf bank_mask:0xf
    v_mov_b32_dpp v5, v34 quad_perm:[2,2,2,2] row_mask:0xf bank_mask:0xf
    s_nop 0
    v_add_f32_dpp v4, v33, v4 quad_perm:[1,1,1,1] row_mask:0xf bank_mask:0xf
    v_add_f32_dpp v5, v35, v5 quad_perm:[3,3,3,3] row_mask:0xf bank_mask:0xf
    v_add_f32 v51, v4, v5
    v_max3_f32 v96, v96, v50, v51
    v_mfma_f32_16x16x32_bf16 v[32:35], a[72:75], v[8:11], 0
    v_mfma_f32_16x16x32_bf16 v[32:35], a[76:79], v[12:15], v[32:35]
    v_mov_b32_dpp v4, v28 quad_perm:[0,0,0,0] row_mask:0xf bank_mask:0xf
    v_mov_b32_dpp v5, v30 quad_perm:[2,2,2,2] row_mask:0xf bank_mask:0xf
    s_nop 0
    v_add_f32_dpp v4, v29, v4 quad_perm:[1,1,1,1] row_mask:0xf bank_mask:0xf
    v_add_f32_dpp v5, v31, v5 quad_perm:[3,3,3,3] row_mask:0xf bank_mask:0xf
    v_add_f32 v52, v4, v5
    s_waitcnt vmcnt(10)
    buffer_load_dwordx4 v[192:195], v1, s[44:47], s68 offen offset:0 nt
    v_mfma_f32_16x16x32_bf16 v[28:31], a[80:83], v[8:11], 0
    v_mfma_f32_16x16x32_bf16 v[28:31], a[84:87], v[12:15], v[28:31]
    v_mov_b32_dpp v4, v32 quad_perm:[0,0,0,0] row_mask:0xf bank_mask:0xf
    v_mov_b32_dpp v5, v34 quad_perm:[2,2,2,2] row_mask:0xf bank_mask:0xf
    s_nop 0
    v_add_f32_dpp v4, v33, v4 quad_perm:[1,1,1,1] row_mask:0xf bank_mask:0xf
    v_add_f32_dpp v5, v35, v5 quad_perm:[3,3,3,3] row_mask:0xf bank_mask:0xf
    v_add_f32 v53, v4, v5
    v_max3_f32 v96, v96, v52, v53
    v_mfma_f32_16x16x32_bf16 v[32:35], a[88:91], v[8:11], 0
    v_mfma_f32_16x16x32_bf16 v[32:35], a[92:95], v[12:15], v[32:35]
    v_mov_b32_dpp v4, v28 quad_perm:[0,0,0,0] row_mask:0xf bank_mask:0xf
    v_mov_b32_dpp v5, v30 quad_perm:[2,2,2,2] row_mask:0xf bank_mask:0xf
    s_nop 0
    v_add_f32_dpp v4, v29, v4 quad_perm:[1,1,1,1] row_mask:0xf bank_mask:0xf
    v_add_f32_dpp v5, v31, v5 quad_perm:[3,3,3,3] row_mask:0xf bank_mask:0xf
    v_add_f32 v54, v4, v5
    s_waitcnt vmcnt(10)
    buffer_load_dwordx4 v[188:191], v1, s[44:47], s68 offen offset:256 nt
    s_add_u32 s68, s68, 6144
    v_mfma_f32_16x16x32_bf16 v[28:31], a[96:99], v[8:11], 0
    v_mfma_f32_16x16x32_bf16 v[28:31], a[100:103], v[12:15], v[28:31]
    v_mov_b32_dpp v4, v32 quad_perm:[0,0,0,0] row_mask:0xf bank_mask:0xf
    v_mov_b32_dpp v5, v34 quad_perm:[2,2,2,2] row_mask:0xf bank_mask:0xf
    s_nop 0
    v_add_f32_dpp v4, v33, v4 quad_perm:[1,1,1,1] row_mask:0xf bank_mask:0xf
    v_add_f32_dpp v5, v35, v5 quad_perm:[3,3,3,3] row_mask:0xf bank_mask:0xf
    v_add_f32 v55, v4, v5
    v_max3_f32 v96, v96, v54, v55
    v_mfma_f32_16x16x32_bf16 v[32:35], a[104:107], v[8:11], 0
    v_mfma_f32_16x16x32_bf16 v[32:35], a[108:111], v[12:15], v[32:35]
    v_mov_b32_dpp v4, v28 quad_perm:[0,0,0,0] row_mask:0xf bank_mask:0xf
    v_mov_b32_dpp v5, v30 quad_perm:[2,2,2,2] row_mask:0xf bank_mask:0xf
    s_nop 0
    v_add_f32_dpp v4, v29, v4 quad_perm:[1,1,1,1] row_mask:0xf bank_mask:0xf
    v_add_f32_dpp v5, v31, v5 quad_perm:[3,3,3,3] row_mask:0xf bank_mask:0xf
    v_add_f32 v56, v4, v5
    s_waitcnt vmcnt(10)
    buffer_load_dwordx4 v[184:187], v1, s[44:47], s68 offen offset:0 nt
    v_mfma_f32_16x16x32_bf16 v[28:31], a[112:115], v[8:11], 0
    v_mfma_f32_16x16x32_bf16 v[28:31], a[116:119], v[12:15], v[28:31]
    v_mov_b32_dpp v4, v32 quad_perm:[0,0,0,0] row_mask:0xf bank_mask:0xf
    v_mov_b32_dpp v5, v34 quad_perm:[2,2,2,2] row_mask:0xf bank_mask:0xf
    s_nop 0
    v_add_f32_dpp v4, v33, v4 quad_perm:[1,1,1,1] row_mask:0xf bank_mask:0xf
    v_add_f32_dpp v5, v35, v5 quad_perm:[3,3,3,3] row_mask:0xf bank_mask:0xf
    v_add_f32 v57, v4, v5
    v_max3_f32 v96, v96, v56, v57
    v_mfma_f32_16x16x32_bf16 v[32:35], a[120:123], v[8:11], 0
    v_mfma_f32_16x16x32_bf16 v[32:35], a[124:127], v[12:15], v[32:35]
    v_mov_b32_dpp v4, v28 quad_perm:[0,0,0,0] row_mask:0xf bank_mask:0xf
    v_mov_b32_dpp v5, v30 quad_perm:[2,2,2,2] row_mask:0xf bank_mask:0xf
    s_nop 0
    v_add_f32_dpp v4, v29, v4 quad_perm:[1,1,1,1] row_mask:0xf bank_mask:0xf
    v_add_f32_dpp v5, v31, v5 quad_perm:[3,3,3,3] row_mask:0xf bank_mask:0xf
    v_add_f32 v58, v4, v5
    s_waitcnt vmcnt(10)
    buffer_load_dwordx4 v[180:183], v1, s[44:47], s68 offen offset:256 nt
    s_add_u32 s68, s68, 6144
    v_mfma_f32_16x16x32_bf16 v[28:31], a[128:131], v[8:11], 0
    v_mfma_f32_16x16x32_bf16 v[28:31], a[132:135], v[12:15], v[28:31]
    v_mov_b32_dpp v4, v32 quad_perm:[0,0,0,0] row_mask:0xf bank_mask:0xf
    v_mov_b32_dpp v5, v34 quad_perm:[2,2,2,2] row_mask:0xf bank_mask:0xf
    s_nop 0
    v_add_f32_dpp v4, v33, v4 quad_perm:[1,1,1,1] row_mask:0xf bank_mask:0xf
    v_add_f32_dpp v5, v35, v5 quad_perm:[3,3,3,3] row_mask:0xf bank_mask:0xf
    v_add_f32 v59, v4, v5
    v_max3_f32 v96, v96, v58, v59
    v_mfma_f32_16x16x32_bf16 v[32:35], a[136:139], v[8:11], 0
    v_mfma_f32_16x16x32_bf16 v[32:35], a[140:143], v[12:15], v[32:35]
    v_mov_b32_dpp v4, v28 quad_perm:[0,0,0,0] row_mask:0xf bank_mask:0xf
    v_mov_b32_dpp v5, v30 quad_perm:[2,2,2,2] row_mask:0xf bank_mask:0xf
    s_cmp_gt_u32 s64, 0
    s_cselect_b64 s[66:67], -1, 0
    v_add_f32_dpp v4, v29, v4 quad_perm:[1,1,1,1] row_mask:0xf bank_mask:0xf
    v_add_f32_dpp v5, v31, v5 quad_perm:[3,3,3,3] row_mask:0xf bank_mask:0xf
    v_add_f32 v60, v4, v5
    v_cndmask_b32 v60, v60, v94, s[66:67]
    s_waitcnt vmcnt(10)
    buffer_load_dwordx4 v[176:179], v1, s[44:47], s68 offen offset:0 nt
    v_mfma_f32_16x16x32_bf16 v[28:31], a[144:147], v[8:11], 0
    v_mfma_f32_16x16x32_bf16 v[28:31], a[148:151], v[12:15], v[28:31]
    v_mov_b32_dpp v4, v32 quad_perm:[0,0,0,0] row_mask:0xf bank_mask:0xf
    v_mov_b32_dpp v5, v34 quad_perm:[2,2,2,2] row_mask:0xf bank_mask:0xf
    s_nop 0
    v_add_f32_dpp v4, v33, v4 quad_perm:[1,1,1,1] row_mask:0xf bank_mask:0xf
    v_add_f32_dpp v5, v35, v5 quad_perm:[3,3,3,3] row_mask:0xf bank_mask:0xf
    v_add_f32 v61, v4, v5
    v_max3_f32 v96, v96, v60, v61
    v_mfma_f32_16x16x32_bf16 v[32:35], a[152:155], v[8:11], 0
    v_mfma_f32_16x16x32_bf16 v[32:35], a[156:159], v[12:15], v[32:35]
    v_mov_b32_dpp v4, v28 quad_perm:[0,0,0,0] row_mask:0xf bank_mask:0xf
    v_mov_b32_dpp v5, v30 quad_perm:[2,2,2,2] row_mask:0xf bank_mask:0xf
    s_nop 0
    v_add_f32_dpp v4, v29, v4 quad_perm:[1,1,1,1] row_mask:0xf bank_mask:0xf
    v_add_f32_dpp v5, v31, v5 quad_perm:[3,3,3,3] row_mask:0xf bank_mask:0xf
    v_add_f32 v62, v4, v5
    s_waitcnt vmcnt(10)
    buffer_load_dwordx4 v[172:175], v1, s[44:47], s68 offen offset:256 nt
    s_add_u32 s68, s68, 6144
    v_mfma_f32_16x16x32_bf16 v[28:31], a[160:163], v[8:11], 0
    v_mfma_f32_16x16x32_bf16 v[28:31], a[164:167], v[12:15], v[28:31]
    v_mov_b32_dpp v4, v32 quad_perm:[0,0,0,0] row_mask:0xf bank_mask:0xf
    v_mov_b32_dpp v5, v34 quad_perm:[2,2,2,2] row_mask:0xf bank_mask:0xf
    s_nop 0
    v_add_f32_dpp v4, v33, v4 quad_perm:[1,1,1,1] row_mask:0xf bank_mask:0xf
    v_add_f32_dpp v5, v35, v5 quad_perm:[3,3,3,3] row_mask:0xf bank_mask:0xf
    v_add_f32 v63, v4, v5
    v_max3_f32 v96, v96, v62, v63
    v_mfma_f32_16x16x32_bf16 v[32:35], a[168:171], v[8:11], 0
    v_mfma_f32_16x16x32_bf16 v[32:35], a[172:175], v[12:15], v[32:35]
    v_mov_b32_dpp v4, v28 quad_perm:[0,0,0,0] row_mask:0xf bank_mask:0xf
    v_mov_b32_dpp v5, v30 quad_perm:[2,2,2,2] row_mask:0xf bank_mask:0xf
    s_nop 0
    v_add_f32_dpp v4, v29, v4 quad_perm:[1,1,1,1] row_mask:0xf bank_mask:0xf
    v_add_f32_dpp v5, v31, v5 quad_perm:[3,3,3,3] row_mask:0xf bank_mask:0xf
    v_add_f32 v64, v4, v5
    s_waitcnt vmcnt(10)
    buffer_load_dwordx4 v[168:171], v1, s[44:47], s68 offen offset:0 nt
    v_mfma_f32_16x16x32_bf16 v[28:31], a[176:179], v[8:11], 0
    v_mfma_f32_16x16x32_bf16 v[28:31], a[180:183], v[12:15], v[28:31]
    v_mov_b32_dpp v4, v32 quad_perm:[0,0,0,0] row_mask:0xf bank_mask:0xf
    v_mov_b32_dpp v5, v34 quad_perm:[2,2,2,2] row_mask:0xf bank_mask:0xf
    s_nop 0
    v_add_f32_dpp v4, v33, v4 quad_perm:[1,1,1,1] row_mask:0xf bank_mask:0xf
    v_add_f32_dpp v5, v35, v5 quad_perm:[3,3,3,3] row_mask:0xf bank_mask:0xf
    v_add_f32 v65, v4, v5
    v_max3_f32 v96, v96, v64, v65
    v_mfma_f32_16x16x32_bf16 v[32:35], a[184:187], v[8:11], 0
    v_mfma_f32_16x16x32_bf16 v[32:35], a[188:191], v[12:15], v[32:35]
    v_mov_b32_dpp v4, v28 quad_perm:[0,0,0,0] row_mask:0xf bank_mask:0xf
    v_mov_b32_dpp v5, v30 quad_perm:[2,2,2,2] row_mask:0xf bank_mask:0xf
    s_nop 0
    v_add_f32_dpp v4, v29, v4 quad_perm:[1,1,1,1] row_mask:0xf bank_mask:0xf
    v_add_f32_dpp v5, v31, v5 quad_perm:[3,3,3,3] row_mask:0xf bank_mask:0xf
    v_add_f32 v66, v4, v5
    s_waitcnt vmcnt(10)
    buffer_load_dwordx4 v[164:167], v1, s[44:47], s68 offen offset:256 nt
    s_add_u32 s68, s68, 6144
    v_mfma_f32_16x16x32_bf16 v[28:31], a[192:195], v[8:11], 0
    v_mfma_f32_16x16x32_bf16 v[28:31], a[196:199], v[12:15], v[28:31]
    v_mov_b32_dpp v4, v32 quad_perm:[0,0,0,0] row_mask:0xf bank_mask:0xf
    v_mov_b32_dpp v5, v34 quad_perm:[2,2,2,2] row_mask:0xf bank_mask:0xf
    s_nop 0
    v_add_f32_dpp v4, v33, v4 quad_perm:[1,1,1,1] row_mask:0xf bank_mask:0xf
    v_add_f32_dpp v5, v35, v5 quad_perm:[3,3,3,3] row_mask:0xf bank_mask:0xf
    v_add_f32 v67, v4, v5
    v_max3_f32 v96, v96, v66, v67
    v_mfma_f32_16x16x32_bf16 v[32:35], a[200:203], v[8:11], 0
    v_mfma_f32_16x16x32_bf16 v[32:35], a[204:207], v[12:15], v[32:35]
    v_mov_b32_dpp v4, v28 quad_perm:[0,0,0,0] row_mask:0xf bank_mask:0xf
    v_mov_b32_dpp v5, v30 quad_perm:[2,2,2,2] row_mask:0xf bank_mask:0xf
    s_nop 0
    v_add_f32_dpp v4, v29, v4 quad_perm:[1,1,1,1] row_mask:0xf bank_mask:0xf
    v_add_f32_dpp v5, v31, v5 quad_perm:[3,3,3,3] row_mask:0xf bank_mask:0xf
    v_add_f32 v68, v4, v5
    s_waitcnt vmcnt(10)
    buffer_load_dwordx4 v[160:163], v1, s[44:47], s68 offen offset:0 nt
    v_mfma_f32_16x16x32_bf16 v[28:31], a[208:211], v[8:11], 0
    v_mfma_f32_16x16x32_bf16 v[28:31], a[212:215], v[12:15], v[28:31]
    v_mov_b32_dpp v4, v32 quad_perm:[0,0,0,0] row_mask:0xf bank_mask:0xf
    v_mov_b32_dpp v5, v34 quad_perm:[2,2,2,2] row_mask:0xf bank_mask:0xf
    s_nop 0
    v_add_f32_dpp v4, v33, v4 quad_perm:[1,1,1,1] row_mask:0xf bank_mask:0xf
    v_add_f32_dpp v5, v35, v5 quad_perm:[3,3,3,3] row_mask:0xf bank_mask:0xf
    v_add_f32 v69, v4, v5
    v_max3_f32 v96, v96, v68, v69
    v_mfma_f32_16x16x32_bf16 v[32:35], a[216:219], v[8:11], 0
    v_mfma_f32_16x16x32_bf16 v[32:35], a[220:223], v[12:15], v[32:35]
    v_mov_b32_dpp v4, v28 quad_perm:[0,0,0,0] row_mask:0xf bank_mask:0xf
    v_mov_b32_dpp v5, v30 quad_perm:[2,2,2,2] row_mask:0xf bank_mask:0xf
    s_nop 0
    v_add_f32_dpp v4, v29, v4 quad_perm:[1,1,1,1] row_mask:0xf bank_mask:0xf
    v_add_f32_dpp v5, v31, v5 quad_perm:[3,3,3,3] row_mask:0xf bank_mask:0xf
    v_add_f32 v70, v4, v5
    s_waitcnt vmcnt(10)
    buffer_load_dwordx4 v[156:159], v1, s[44:47], s68 offen offset:256 nt
    s_add_u32 s68, s68, 6144
    v_mfma_f32_16x16x32_bf16 v[28:31], a[224:227], v[8:11], 0
    v_mfma_f32_16x16x32_bf16 v[28:31], a[228:231], v[12:15], v[28:31]
    v_mov_b32_dpp v4, v32 quad_perm:[0,0,0,0] row_mask:0xf bank_mask:0xf
    v_mov_b32_dpp v5, v34 quad_perm:[2,2,2,2] row_mask:0xf bank_mask:0xf
    s_nop 0
    v_add_f32_dpp v4, v33, v4 quad_perm:[1,1,1,1] row_mask:0xf bank_mask:0xf
    v_add_f32_dpp v5, v35, v5 quad_perm:[3,3,3,3] row_mask:0xf bank_mask:0xf
    v_add_f32 v71, v4, v5
    v_max3_f32 v96, v96, v70, v71
    v_mfma_f32_16x16x32_bf16 v[32:35], a[232:235], v[8:11], 0
    v_mfma_f32_16x16x32_bf16 v[32:35], a[236:239], v[12:15], v[32:35]
    v_mov_b32_dpp v4, v28 quad_perm:[0,0,0,0] row_mask:0xf bank_mask:0xf
    v_mov_b32_dpp v5, v30 quad_perm:[2,2,2,2] row_mask:0xf bank_mask:0xf
    s_nop 0
    v_add_f32_dpp v4, v29, v4 quad_perm:[1,1,1,1] row_mask:0xf bank_mask:0xf
    v_add_f32_dpp v5, v31, v5 quad_perm:[3,3,3,3] row_mask:0xf bank_mask:0xf
    v_add_f32 v72, v4, v5
    s_cmp_gt_u32 s64, 0
    s_cbranch_scc1 L_skip3
    s_waitcnt vmcnt(10)
    buffer_load_dwordx4 v[152:155], v2, s[48:51], s69 offen offset:0 nt
L_skip3:
    v_mfma_f32_16x16x32_bf16 v[28:31], a[240:243], v[8:11], 0
    v_mfma_f32_16x16x32_bf16 v[28:31], a[244:247], v[12:15], v[28:31]
    v_mov_b32_dpp v4, v32 quad_perm:[0,0,0,0] row_mask:0xf bank_mask:0xf
    v_mov_b32_dpp v5, v34 quad_perm:[2,2,2,2] row_mask:0xf bank_mask:0xf
    s_nop 0
    v_add_f32_dpp v4, v33, v4 quad_perm:[1,1,1,1] row_mask:0xf bank_mask:0xf
    v_add_f32_dpp v5, v35, v5 quad_perm:[3,3,3,3] row_mask:0xf bank_mask:0xf
    v_add_f32 v73, v4, v5
    v_max3_f32 v96, v96, v72, v73
    v_mfma_f32_16x16x32_bf16 v[32:35], a[248:251], v[8:11], 0
    v_mfma_f32_16x16x32_bf16 v[32:35], a[252:255], v[12:15], v[32:35]
    v_mov_b32_dpp v4, v28 quad_perm:[0,0,0,0] row_mask:0xf bank_mask:0xf
    v_mov_b32_dpp v5, v30 quad_perm:[2,2,2,2] row_mask:0xf bank_mask:0xf
    s_nop 0
    v_add_f32_dpp v4, v29, v4 quad_perm:[1,1,1,1] row_mask:0xf bank_mask:0xf
    v_add_f32_dpp v5, v31, v5 quad_perm:[3,3,3,3] row_mask:0xf bank_mask:0xf
    v_add_f32 v74, v4, v5
    s_cmp_gt_u32 s64, 0
    s_cbranch_scc1 L_skip4
    s_waitcnt vmcnt(10)
    buffer_load_dwordx4 v[148:151], v2, s[48:51], s69 offen offset:256 nt
    s_add_u32 s69, s69, 6144
L_skip4:
    v_mfma_f32_16x16x32_bf16 v[28:31], v[240:243], v[8:11], 0
    v_mfma_f32_16x16x32_bf16 v[28:31], v[236:239], v[12:15], v[28:31]
    v_mov_b32_dpp v4, v32 quad_perm:[0,0,0,0] row_mask:0xf bank_mask:0xf
    v_mov_b32_dpp v5, v34 quad_perm:[2,2,2,2] row_mask:0xf bank_mask:0xf
    s_nop 0
    v_add_f32_dpp v4, v33, v4 quad_perm:[1,1,1,1] row_mask:0xf bank_mask:0xf
    v_add_f32_dpp v5, v35, v5 quad_perm:[3,3,3,3] row_mask:0xf bank_mask:0xf
    v_add_f32 v75, v4, v5
    v_max3_f32 v96, v96, v74, v75
    v_mfma_f32_16x16x32_bf16 v[32:35], v[232:235], v[8:11], 0
    v_mfma_f32_16x16x32_bf16 v[32:35], v[228:231], v[12:15], v[32:35]
    v_mov_b32_dpp v4, v28 quad_perm:[0,0,0,0] row_mask:0xf bank_mask:0xf
    v_mov_b32_dpp v5, v30 quad_perm:[2,2,2,2] row_mask:0xf bank_mask:0xf
    s_nop 0
    v_add_f32_dpp v4, v29, v4 quad_perm:[1,1,1,1] row_mask:0xf bank_mask:0xf
    v_add_f32_dpp v5, v31, v5 quad_perm:[3,3,3,3] row_mask:0xf bank_mask:0xf
    v_add_f32 v76, v4, v5
    s_waitcnt vmcnt(10)
    buffer_load_dwordx4 v[144:147], v2, s[48:51], s69 offen offset:0 nt
    v_mfma_f32_16x16x32_bf16 v[28:31], v[224:227], v[8:11], 0
    v_mfma_f32_16x16x32_bf16 v[28:31], v[220:223], v[12:15], v[28:31]
    v_mov_b32_dpp v4, v32 quad_perm:[0,0,0,0] row_mask:0xf bank_mask:0xf
    v_mov_b32_dpp v5, v34 quad_perm:[2,2,2,2] row_mask:0xf bank_mask:0xf
    s_nop 0
    v_add_f32_dpp v4, v33, v4 quad_perm:[1,1,1,1] row_mask:0xf bank_mask:0xf
    v_add_f32_dpp v5, v35, v5 quad_perm:[3,3,3,3] row_mask:0xf bank_mask:0xf
    v_add_f32 v77, v4, v5
    v_max3_f32 v96, v96, v76, v77
    v_mfma_f32_16x16x32_bf16 v[32:35], v[216:219], v[8:11], 0
    v_mfma_f32_16x16x32_bf16 v[32:35], v[212:215], v[12:15], v[32:35]
    v_mov_b32_dpp v4, v28 quad_perm:[0,0,0,0] row_mask:0xf bank_mask:0xf
    v_mov_b32_dpp v5, v30 quad_perm:[2,2,2,2] row_mask:0xf bank_mask:0xf
    s_nop 0
    v_add_f32_dpp v4, v29, v4 quad_perm:[1,1,1,1] row_mask:0xf bank_mask:0xf
    v_add_f32_dpp v5, v31, v5 quad_perm:[3,3,3,3] row_mask:0xf bank_mask:0xf
    v_add_f32 v78, v4, v5
    s_waitcnt vmcnt(10)
    buffer_load_dwordx4 v[140:143], v2, s[48:51], s69 offen offset:256 nt
    s_add_u32 s69, s69, 6144
    v_mfma_f32_16x16x32_bf16 v[28:31], v[208:211], v[8:11], 0
    v_mfma_f32_16x16x32_bf16 v[28:31], v[204:207], v[12:15], v[28:31]
    v_mov_b32_dpp v4, v32 quad_perm:[0,0,0,0] row_mask:0xf bank_mask:0xf
    v_mov_b32_dpp v5, v34 quad_perm:[2,2,2,2] row_mask:0xf bank_mask:0xf
    s_nop 0
    v_add_f32_dpp v4, v33, v4 quad_perm:[1,1,1,1] row_mask:0xf bank_mask:0xf
    v_add_f32_dpp v5, v35, v5 quad_perm:[3,3,3,3] row_mask:0xf bank_mask:0xf
    v_add_f32 v79, v4, v5
    v_max3_f32 v96, v96, v78, v79
    v_mfma_f32_16x16x32_bf16 v[32:35], v[200:203], v[8:11], 0
    v_mfma_f32_16x16x32_bf16 v[32:35], v[196:199], v[12:15], v[32:35]
    v_mov_b32_dpp v4, v28 quad_perm:[0,0,0,0] row_mask:0xf bank_mask:0xf
    v_mov_b32_dpp v5, v30 quad_perm:[2,2,2,2] row_mask:0xf bank_mask:0xf
    s_nop 0
    v_add_f32_dpp v4, v29, v4 quad_perm:[1,1,1,1] row_mask:0xf bank_mask:0xf
    v_add_f32_dpp v5, v31, v5 quad_perm:[3,3,3,3] row_mask:0xf bank_mask:0xf
    v_add_f32 v80, v4, v5
    s_waitcnt vmcnt(10)
    buffer_load_dwordx4 v[136:139], v2, s[48:51], s69 offen offset:0 nt
    v_mfma_f32_16x16x32_bf16 v[28:31], v[192:195], v[8:11], 0
    v_mfma_f32_16x16x32_bf16 v[28:31], v[188:191], v[12:15], v[28:31]
    v_mov_b32_dpp v4, v32 quad_perm:[0,0,0,0] row_mask:0xf bank_mask:0xf
    v_mov_b32_dpp v5, v34 quad_perm:[2,2,2,2] row_mask:0xf bank_mask:0xf
    s_nop 0
    v_add_f32_dpp v4, v33, v4 quad_perm:[1,1,1,1] row_mask:0xf bank_mask:0xf
    v_add_f32_dpp v5, v35, v5 quad_perm:[3,3,3,3] row_mask:0xf bank_mask:0xf
    v_add_f32 v81, v4, v5
    v_max3_f32 v96, v96, v80, v81
    s_waitcnt vmcnt(10)
    buffer_load_dwordx4 v[132:135], v2, s[48:51], s69 offen offset:256 nt
    s_add_u32 s69, s69, 6144
    s_waitcnt vmcnt(10)
    buffer_load_dwordx4 v[128:131], v2, s[48:51], s69 offen offset:0 nt
    v_mfma_f32_16x16x32_bf16 v[32:35], v[184:187], v[8:11], 0
    v_mfma_f32_16x16x32_bf16 v[32:35], v[180:183], v[12:15], v[32:35]
    v_mov_b32_dpp v4, v28 quad_perm:[0,0,0,0] row_mask:0xf bank_mask:0xf
    v_mov_b32_dpp v5, v30 quad_perm:[2,2,2,2] row_mask:0xf bank_mask:0xf
    s_nop 0
    v_add_f32_dpp v4, v29, v4 quad_perm:[1,1,1,1] row_mask:0xf bank_mask:0xf
    v_add_f32_dpp v5, v31, v5 quad_perm:[3,3,3,3] row_mask:0xf bank_mask:0xf
    v_add_f32 v82, v4, v5
    s_waitcnt vmcnt(10)
    buffer_load_dwordx4 v[124:127], v2, s[48:51], s69 offen offset:256 nt
    s_add_u32 s69, s69, 6144
    s_waitcnt vmcnt(10)
    buffer_load_dwordx4 v[120:123], v2, s[48:51], s69 offen offset:0 nt
    v_mfma_f32_16x16x32_bf16 v[28:31], v[176:179], v[8:11], 0
    v_mfma_f32_16x16x32_bf16 v[28:31], v[172:175], v[12:15], v[28:31]
    v_mov_b32_dpp v4, v32 quad_perm:[0,0,0,0] row_mask:0xf bank_mask:0xf
    v_mov_b32_dpp v5, v34 quad_perm:[2,2,2,2] row_mask:0xf bank_mask:0xf
    s_nop 0
    v_add_f32_dpp v4, v33, v4 quad_perm:[1,1,1,1] row_mask:0xf bank_mask:0xf
    v_add_f32_dpp v5, v35, v5 quad_perm:[3,3,3,3] row_mask:0xf bank_mask:0xf
    v_add_f32 v83, v4, v5
    v_max3_f32 v96, v96, v82, v83
    s_waitcnt vmcnt(10)
    buffer_load_dwordx4 v[116:119], v2, s[48:51], s69 offen offset:256 nt
    s_add_u32 s69, s69, 6144
    s_waitcnt vmcnt(10)
    buffer_load_dwordx4 v[112:115], v2, s[48:51], s69 offen offset:0 nt
    v_mfma_f32_16x16x32_bf16 v[32:35], v[168:171], v[8:11], 0
    v_mfma_f32_16x16x32_bf16 v[32:35], v[164:167], v[12:15], v[32:35]
    v_mov_b32_dpp v4, v28 quad_perm:[0,0,0,0] row_mask:0xf bank_mask:0xf
    v_mov_b32_dpp v5, v30 quad_perm:[2,2,2,2] row_mask:0xf bank_mask:0xf
    s_nop 0
    v_add_f32_dpp v4, v29, v4 quad_perm:[1,1,1,1] row_mask:0xf bank_mask:0xf
    v_add_f32_dpp v5, v31, v5 quad_perm:[3,3,3,3] row_mask:0xf bank_mask:0xf
    v_add_f32 v84, v4, v5
    s_waitcnt vmcnt(10)
    buffer_load_dwordx4 v[108:111], v2, s[48:51], s69 offen offset:256 nt
    s_add_u32 s69, s69, 6144
    s_waitcnt vmcnt(10)
    buffer_load_dwordx4 v[104:107], v2, s[48:51], s69 offen offset:0 nt
    v_mfma_f32_16x16x32_bf16 v[28:31], v[160:163], v[8:11], 0
    v_mfma_f32_16x16x32_bf16 v[28:31], v[156:159], v[12:15], v[28:31]
    v_mov_b32_dpp v4, v32 quad_perm:[0,0,0,0] row_mask:0xf bank_mask:0xf
    v_mov_b32_dpp v5, v34 quad_perm:[2,2,2,2] row_mask:0xf bank_mask:0xf
    s_nop 0
    v_add_f32_dpp v4, v33, v4 quad_perm:[1,1,1,1] row_mask:0xf bank_mask:0xf
    v_add_f32_dpp v5, v35, v5 quad_perm:[3,3,3,3] row_mask:0xf bank_mask:0xf
    v_add_f32 v85, v4, v5
    v_max3_f32 v96, v96, v84, v85
    s_nop 0
    v_mov_b32_dpp v4, v28 quad_perm:[0,0,0,0] row_mask:0xf bank_mask:0xf
    v_mov_b32_dpp v5, v30 quad_perm:[2,2,2,2] row_mask:0xf bank_mask:0xf
    s_nop 0
    v_add_f32_dpp v4, v29, v4 quad_perm:[1,1,1,1] row_mask:0xf bank_mask:0xf
    v_add_f32_dpp v5, v31, v5 quad_perm:[3,3,3,3] row_mask:0xf bank_mask:0xf
    v_add_f32 v86, v4, v5
    v_max_f32 v96, v96, v86
    s_waitcnt vmcnt(10)
    buffer_load_dwordx4 v[100:103], v2, s[48:51], s69 offen offset:256 nt
    s_add_u32 s69, s69, 6144
    v_mov_b32 v4, v96
    s_nop 1
    v_permlane16_swap_b32 v96, v4
    v_max_f32 v96, v96, v4
    v_mov_b32 v4, v96
    s_nop 1
    v_permlane32_swap_b32 v96, v4
    v_max_f32 v96, v96, v4
    v_cvt_pk_bf16_f32 v96, v96, v96
    v_and_b32 v96, 0xffff0000, v96
    s_mov_b32 s12, 1035512379
    v_mov_b32 v98, 0
    v_mov_b32 v99, 0
    v_mov_b32 v29, v97
    v_mov_b32 v31, v97
    v_mov_b32 v33, v97
    v_mov_b32 v35, v97
    v_mov_b32 v37, v97
    v_mov_b32 v39, v97
    v_mov_b32 v41, v97
    v_mov_b32 v43, v97
    v_lshrrev_b32 v95, 3, v0
    v_lshlrev_b32 v95, 4, v95
    s_mul_i32 s78, s8, 12288
    s_add_u32 s78, s78, 2621440
    s_mul_i32 s66, s7, 3
    s_add_u32 s66, s66, s13
    s_mul_i32 s66, s66, 128
    s_add_u32 s66, s66, s78
    v_cvt_pk_bf16_f32 v28, v44, v45
    v_lshlrev_b32 v44, 16, v28
    v_and_b32 v45, 0xffff0000, v28
    v_sub_f32 v44, v44, v96
    v_sub_f32 v45, v45, v96
    v_mul_f32 v44, s12, v44
    v_mul_f32 v45, s12, v45
    v_exp_f32 v44, v44
    v_exp_f32 v45, v45
    v_add_f32 v98, v98, v44
    v_add_f32 v99, v99, v45
    v_cvt_pk_bf16_f32 v30, v46, v47
    s_mov_b32 exec_lo, 0x01010101
    s_mov_b32 exec_hi, 0x01010101
    buffer_store_dwordx4 v[28:31], v95, s[40:43], s66 offen sc1
    s_mov_b64 exec, -1
    s_add_u32 s66, s66, 3072
    v_lshlrev_b32 v46, 16, v30
    v_and_b32 v47, 0xffff0000, v30
    v_sub_f32 v46, v46, v96
    v_sub_f32 v47, v47, v96
    v_mul_f32 v46, s12, v46
    v_mul_f32 v47, s12, v47
    v_exp_f32 v46, v46
    v_exp_f32 v47, v47
    v_add_f32 v98, v98, v46
    v_add_f32 v99, v99, v47
    s_waitcnt vmcnt(10)
    buffer_load_dwordx4 a[0:3], v2, s[48:51], s69 offen offset:0 nt
    v_cvt_pk_bf16_f32 v32, v48, v49
    v_lshlrev_b32 v48, 16, v32
    v_and_b32 v49, 0xffff0000, v32
    v_sub_f32 v48, v48, v96
    v_sub_f32 v49, v49, v96
    v_mul_f32 v48, s12, v48
    v_mul_f32 v49, s12, v49
    v_exp_f32 v48, v48
    v_exp_f32 v49, v49
    v_add_f32 v98, v98, v48
    v_add_f32 v99, v99, v49
    v_cvt_pk_bf16_f32 v34, v50, v51
    s_mov_b32 exec_lo, 0x01010101
    s_mov_b32 exec_hi, 0x01010101
    buffer_store_dwordx4 v[32:35], v95, s[40:43], s66 offen sc1
    s_mov_b64 exec, -1
    s_add_u32 s66, s66, 3072
    v_lshlrev_b32 v50, 16, v34
    v_and_b32 v51, 0xffff0000, v34
    v_sub_f32 v50, v50, v96
    v_sub_f32 v51, v51, v96
    v_mul_f32 v50, s12, v50
    v_mul_f32 v51, s12, v51
    v_exp_f32 v50, v50
    v_exp_f32 v51, v51
    v_add_f32 v98, v98, v50
    v_add_f32 v99, v99, v51
    s_waitcnt vmcnt(10)
    buffer_load_dwordx4 a[4:7], v2, s[48:51], s69 offen offset:256 nt
    s_add_u32 s69, s69, 6144
    v_cvt_pk_bf16_f32 v36, v52, v53
    v_lshlrev_b32 v52, 16, v36
    v_and_b32 v53, 0xffff0000, v36
    v_sub_f32 v52, v52, v96
    v_sub_f32 v53, v53, v96
    v_mul_f32 v52, s12, v52
    v_mul_f32 v53, s12, v53
    v_exp_f32 v52, v52
    v_exp_f32 v53, v53
    v_add_f32 v98, v98, v52
    v_add_f32 v99, v99, v53
    v_cvt_pk_bf16_f32 v38, v54, v55
    s_mov_b32 exec_lo, 0x01010101
    s_mov_b32 exec_hi, 0x01010101
    buffer_store_dwordx4 v[36:39], v95, s[40:43], s66 offen sc1
    s_mov_b64 exec, -1
    s_add_u32 s66, s66, 3072
    v_lshlrev_b32 v54, 16, v38
    v_and_b32 v55, 0xffff0000, v38
    v_sub_f32 v54, v54, v96
    v_sub_f32 v55, v55, v96
    v_mul_f32 v54, s12, v54
    v_mul_f32 v55, s12, v55
    v_exp_f32 v54, v54
    v_exp_f32 v55, v55
    v_add_f32 v98, v98, v54
    v_add_f32 v99, v99, v55
    s_waitcnt vmcnt(10)
    buffer_load_dwordx4 a[8:11], v2, s[48:51], s69 offen offset:0 nt
    v_cvt_pk_bf16_f32 v40, v56, v57
    v_lshlrev_b32 v56, 16, v40
    v_and_b32 v57, 0xffff0000, v40
    v_sub_f32 v56, v56, v96
    v_sub_f32 v57, v57, v96
    v_mul_f32 v56, s12, v56
    v_mul_f32 v57, s12, v57
    v_exp_f32 v56, v56
    v_exp_f32 v57, v57
    v_add_f32 v98, v98, v56
    v_add_f32 v99, v99, v57
    v_cvt_pk_bf16_f32 v42, v58, v59
    s_mov_b32 exec_lo, 0x01010101
    s_mov_b32 exec_hi, 0x01010101
    buffer_store_dwordx4 v[40:43], v95, s[40:43], s66 offen sc1
    s_mov_b64 exec, -1
    s_add_u32 s66, s66, 3072
    v_lshlrev_b32 v58, 16, v42
    v_and_b32 v59, 0xffff0000, v42
    v_sub_f32 v58, v58, v96
    v_sub_f32 v59, v59, v96
    v_mul_f32 v58, s12, v58
    v_mul_f32 v59, s12, v59
    v_exp_f32 v58, v58
    v_exp_f32 v59, v59
    v_add_f32 v98, v98, v58
    v_add_f32 v99, v99, v59
    s_waitcnt vmcnt(10)
    buffer_load_dwordx4 a[12:15], v2, s[48:51], s69 offen offset:256 nt
    s_add_u32 s69, s69, 6144
    v_cvt_pk_bf16_f32 v4, v60, v61
    v_lshlrev_b32 v60, 16, v4
    v_and_b32 v61, 0xffff0000, v4
    v_sub_f32 v60, v60, v96
    v_sub_f32 v61, v61, v96
    v_mul_f32 v60, s12, v60
    v_mul_f32 v61, s12, v61
    v_exp_f32 v60, v60
    v_exp_f32 v61, v61
    v_add_f32 v98, v98, v60
    v_add_f32 v99, v99, v61
    v_cvt_pk_bf16_f32 v60, v60, v60
    v_cvt_pk_bf16_f32 v61, v61, v61
    v_cvt_pk_bf16_f32 v4, v62, v63
    v_lshlrev_b32 v62, 16, v4
    v_and_b32 v63, 0xffff0000, v4
    v_sub_f32 v62, v62, v96
    v_sub_f32 v63, v63, v96
    v_mul_f32 v62, s12, v62
    v_mul_f32 v63, s12, v63
    v_exp_f32 v62, v62
    v_exp_f32 v63, v63
    v_add_f32 v98, v98, v62
    v_add_f32 v99, v99, v63
    v_cvt_pk_bf16_f32 v62, v62, v62
    v_cvt_pk_bf16_f32 v63, v63, v63
    s_waitcnt vmcnt(10)
    buffer_load_dwordx4 a[16:19], v2, s[48:51], s69 offen offset:0 nt
    v_cvt_pk_bf16_f32 v4, v64, v65
    v_lshlrev_b32 v64, 16, v4
    v_and_b32 v65, 0xffff0000, v4
    v_sub_f32 v64, v64, v96
    v_sub_f32 v65, v65, v96
    v_mul_f32 v64, s12, v64
    v_mul_f32 v65, s12, v65
    v_exp_f32 v64, v64
    v_exp_f32 v65, v65
    v_add_f32 v98, v98, v64
    v_add_f32 v99, v99, v65
    v_cvt_pk_bf16_f32 v64, v64, v64
    v_cvt_pk_bf16_f32 v65, v65, v65
    v_cvt_pk_bf16_f32 v4, v66, v67
    v_lshlrev_b32 v66, 16, v4
    v_and_b32 v67, 0xffff0000, v4
    v_sub_f32 v66, v66, v96
    v_sub_f32 v67, v67, v96
    v_mul_f32 v66, s12, v66
    v_mul_f32 v67, s12, v67
    v_exp_f32 v66, v66
    v_exp_f32 v67, v67
    v_add_f32 v98, v98, v66
    v_add_f32 v99, v99, v67
    v_cvt_pk_bf16_f32 v66, v66, v66
    v_cvt_pk_bf16_f32 v67, v67, v67
    s_waitcnt vmcnt(10)
    buffer_load_dwordx4 a[20:23], v2, s[48:51], s69 offen offset:256 nt
    s_add_u32 s69, s69, 6144
    v_cvt_pk_bf16_f32 v4, v68, v69
    v_lshlrev_b32 v68, 16, v4
    v_and_b32 v69, 0xffff0000, v4
    v_sub_f32 v68, v68, v96
    v_sub_f32 v69, v69, v96
    v_mul_f32 v68, s12, v68
    v_mul_f32 v69, s12, v69
    v_exp_f32 v68, v68
    v_exp_f32 v69, v69
    v_add_f32 v98, v98, v68
    v_add_f32 v99, v99, v69
    v_cvt_pk_bf16_f32 v68, v68, v68
    v_cvt_pk_bf16_f32 v69, v69, v69
    v_cvt_pk_bf16_f32 v4, v70, v71
    v_lshlrev_b32 v70, 16, v4
    v_and_b32 v71, 0xffff0000, v4
    v_sub_f32 v70, v70, v96
    v_sub_f32 v71, v71, v96
    v_mul_f32 v70, s12, v70
    v_mul_f32 v71, s12, v71
    v_exp_f32 v70, v70
    v_exp_f32 v71, v71
    v_add_f32 v98, v98, v70
    v_add_f32 v99, v99, v71
    v_cvt_pk_bf16_f32 v70, v70, v70
    v_cvt_pk_bf16_f32 v71, v71, v71
    s_waitcnt vmcnt(10)
    buffer_load_dwordx4 a[24:27], v2, s[48:51], s69 offen offset:0 nt
    v_cvt_pk_bf16_f32 v4, v72, v73
    v_lshlrev_b32 v72, 16, v4
    v_and_b32 v73, 0xffff0000, v4
    v_sub_f32 v72, v72, v96
    v_sub_f32 v73, v73, v96
    v_mul_f32 v72, s12, v72
    v_mul_f32 v73, s12, v73
    v_exp_f32 v72, v72
    v_exp_f32 v73, v73
    v_add_f32 v98, v98, v72
    v_add_f32 v99, v99, v73
    v_cvt_pk_bf16_f32 v72, v72, v72
    v_cvt_pk_bf16_f32 v73, v73, v73
    v_cvt_pk_bf16_f32 v4, v74, v75
    v_lshlrev_b32 v74, 16, v4
    v_and_b32 v75, 0xffff0000, v4
    v_sub_f32 v74, v74, v96
    v_sub_f32 v75, v75, v96
    v_mul_f32 v74, s12, v74
    v_mul_f32 v75, s12, v75
    v_exp_f32 v74, v74
    v_exp_f32 v75, v75
    v_add_f32 v98, v98, v74
    v_add_f32 v99, v99, v75
    v_cvt_pk_bf16_f32 v74, v74, v74
    v_cvt_pk_bf16_f32 v75, v75, v75
    s_waitcnt vmcnt(10)
    buffer_load_dwordx4 a[28:31], v2, s[48:51], s69 offen offset:256 nt
    s_add_u32 s69, s69, 6144
    v_cvt_pk_bf16_f32 v4, v76, v77
    v_lshlrev_b32 v76, 16, v4
    v_and_b32 v77, 0xffff0000, v4
    v_sub_f32 v76, v76, v96
    v_sub_f32 v77, v77, v96
    v_mul_f32 v76, s12, v76
    v_mul_f32 v77, s12, v77
    v_exp_f32 v76, v76
    v_exp_f32 v77, v77
    v_add_f32 v98, v98, v76
    v_add_f32 v99, v99, v77
    v_cvt_pk_bf16_f32 v76, v76, v76
    v_cvt_pk_bf16_f32 v77, v77, v77
    v_cvt_pk_bf16_f32 v4, v78, v79
    v_lshlrev_b32 v78, 16, v4
    v_and_b32 v79, 0xffff0000, v4
    v_sub_f32 v78, v78, v96
    v_sub_f32 v79, v79, v96
    v_mul_f32 v78, s12, v78
    v_mul_f32 v79, s12, v79
    v_exp_f32 v78, v78
    v_exp_f32 v79, v79
    v_add_f32 v98, v98, v78
    v_add_f32 v99, v99, v79
    v_cvt_pk_bf16_f32 v78, v78, v78
    v_cvt_pk_bf16_f32 v79, v79, v79
    s_waitcnt vmcnt(10)
    buffer_load_dwordx4 a[32:35], v2, s[48:51], s69 offen offset:0 nt
    v_cvt_pk_bf16_f32 v4, v80, v81
    v_lshlrev_b32 v80, 16, v4
    v_and_b32 v81, 0xffff0000, v4
    v_sub_f32 v80, v80, v96
    v_sub_f32 v81, v81, v96
    v_mul_f32 v80, s12, v80
    v_mul_f32 v81, s12, v81
    v_exp_f32 v80, v80
    v_exp_f32 v81, v81
    v_add_f32 v98, v98, v80
    v_add_f32 v99, v99, v81
    v_cvt_pk_bf16_f32 v80, v80, v80
    v_cvt_pk_bf16_f32 v81, v81, v81
    v_cvt_pk_bf16_f32 v4, v82, v83
    v_lshlrev_b32 v82, 16, v4
    v_and_b32 v83, 0xffff0000, v4
    v_sub_f32 v82, v82, v96
    v_sub_f32 v83, v83, v96
    v_mul_f32 v82, s12, v82
    v_mul_f32 v83, s12, v83
    v_exp_f32 v82, v82
    v_exp_f32 v83, v83
    v_add_f32 v98, v98, v82
    v_add_f32 v99, v99, v83
    v_cvt_pk_bf16_f32 v82, v82, v82
    v_cvt_pk_bf16_f32 v83, v83, v83
    s_waitcnt vmcnt(10)
    buffer_load_dwordx4 a[36:39], v2, s[48:51], s69 offen offset:256 nt
    s_add_u32 s69, s69, 6144
    v_cvt_pk_bf16_f32 v4, v84, v85
    v_lshlrev_b32 v84, 16, v4
    v_and_b32 v85, 0xffff0000, v4
    v_sub_f32 v84, v84, v96
    v_sub_f32 v85, v85, v96
    v_mul_f32 v84, s12, v84
    v_mul_f32 v85, s12, v85
    v_exp_f32 v84, v84
    v_exp_f32 v85, v85
    v_add_f32 v98, v98, v84
    v_add_f32 v99, v99, v85
    v_cvt_pk_bf16_f32 v84, v84, v84
    v_cvt_pk_bf16_f32 v85, v85, v85
    v_cvt_pk_bf16_f32 v4, v86, v87
    v_lshlrev_b32 v86, 16, v4
    v_and_b32 v87, 0xffff0000, v4
    v_sub_f32 v86, v86, v96
    v_sub_f32 v87, v87, v96
    v_mul_f32 v86, s12, v86
    v_mul_f32 v87, s12, v87
    v_exp_f32 v86, v86
    v_exp_f32 v87, v87
    v_add_f32 v98, v98, v86
    v_add_f32 v99, v99, v87
    v_cvt_pk_bf16_f32 v86, v86, v86
    v_cvt_pk_bf16_f32 v87, v87, v87
    s_waitcnt vmcnt(10)
    buffer_load_dwordx4 a[40:43], v2, s[48:51], s69 offen offset:0 nt
    v_add_f32 v98, v98, v99
    v_mov_b32 v4, v98
    s_nop 1
    v_permlane16_swap_b32 v98, v4
    v_add_f32 v98, v98, v4
    v_mov_b32 v4, v98
    s_nop 1
    v_permlane32_swap_b32 v98, v4
    v_add_f32 v98, v98, v4
    s_waitcnt vmcnt(10)
    buffer_load_dwordx4 a[44:47], v2, s[48:51], s69 offen offset:256 nt
    s_add_u32 s69, s69, 6144
    v_mov_b32 v99, v97
    v_lshlrev_b32 v4, 1, v0
    s_lshl_b32 s12, s8, 10
    s_lshl_b32 s66, s7, 2
    s_add_u32 s66, s66, s13
    s_lshl_b32 s66, s66, 5
    s_add_u32 s12, s12, s66
    s_add_u32 s12, s12, 655360
    s_mov_b64 exec, 0x101
    buffer_store_dwordx4 v[96:99], v4, s[40:43], s12 offen sc1
    s_mov_b64 exec, -1
    s_lshl_b32 s12, s8, 8
    s_add_u32 s12, s12, 786432
    s_add_u32 s80, s38, s12
    s_addc_u32 s81, s39, 0
    s_mov_b32 s67, 1035512379
    s_mov_b32 s63, 200000
    s_waitcnt vmcnt(10)
    buffer_load_dwordx4 a[48:51], v2, s[48:51], s69 offen offset:0 nt
    v_lshrrev_b32 v4, 5, v0
    v_lshlrev_b32 v8, 2, v4
    v_add_u32 v8, 5184, v8
    v_lshlrev_b32 v5, 7, v4
    v_bfe_u32 v6, v0, 2, 2
    v_lshl_add_u32 v5, v6, 11, v5
    v_and_b32 v6, 3, v0
    v_lshl_add_u32 v5, v6, 5, v5
    v_bfe_u32 v6, v0, 4, 1
    v_lshl_add_u32 v5, v6, 4, v5
    s_lshl_b32 s71, s8, 14
    s_lshl_b32 s12, s7, 8
    s_add_u32 s71, s71, s12
    s_add_u32 s71, s71, 1048576
    s_xor_b32 s71, s71, s62
    s_xor_b32 s73, s71, 8192
    v_and_b32 v7, 15, v0
    v_lshlrev_b32 v7, 11, v7
    v_lshl_add_u32 v7, v6, 4, v7
    v_xor_b32 v7, s62, v7
    s_lshl_b32 s72, s6, 17
    s_lshl_b32 s12, s9, 5
    s_add_u32 s72, s72, s12
    s_add_u32 s72, s72, 1572864
    s_lshl_b32 s12, s13, 15
    s_add_u32 s72, s72, s12
    v_lshlrev_b32 v6, 4, v0
    s_lshl_b32 s12, s13, 11
    s_add_u32 s12, s12, 66560
    v_add_u32 v4, s12, v6
    s_cmp_eq_u32 s13, 0
    s_mov_b32 s12, 66560
    s_cselect_b32 s12, 68608, s12
    v_add_u32 v14, s12, v6
    s_cmp_eq_u32 s13, 2
    s_mov_b32 s12, 70656
    s_cselect_b32 s12, 68608, s12
    v_add_u32 v15, s12, v6
    v_bfe_u32 v6, v0, 3, 1
    v_lshlrev_b32 v6, 7, v6
    v_lshrrev_b32 v9, 4, v0
    v_lshl_add_u32 v6, v9, 5, v6
    s_cmp_gt_u32 s64, 0
    s_cbranch_scc1 L_skip5
    v_and_b32 v36, v16, v60
    v_and_b32 v37, v17, v60
    v_and_b32 v38, v18, v60
    v_and_b32 v39, v19, v60
    s_nop 1
    v_mfma_f32_16x16x32_bf16 v[20:23], v[36:39], v[152:155], v[20:23]
    v_mfma_f32_16x16x32_bf16 v[24:27], v[36:39], v[148:151], v[24:27]
L_skip5:
    s_waitcnt vmcnt(10)
    buffer_load_dwordx4 a[52:55], v2, s[48:51], s69 offen offset:256 nt
    s_add_u32 s69, s69, 6144
    v_and_b32 v40, v16, v61
    v_and_b32 v41, v17, v61
    v_and_b32 v42, v18, v61
    v_and_b32 v43, v19, v61
    s_nop 1
    v_mfma_f32_16x16x32_bf16 v[20:23], v[40:43], v[144:147], v[20:23]
    v_mfma_f32_16x16x32_bf16 v[24:27], v[40:43], v[140:143], v[24:27]
    v_and_b32 v36, v16, v62
    v_and_b32 v37, v17, v62
    v_and_b32 v38, v18, v62
    v_and_b32 v39, v19, v62
    s_nop 1
    v_mfma_f32_16x16x32_bf16 v[20:23], v[36:39], v[136:139], v[20:23]
    v_mfma_f32_16x16x32_bf16 v[24:27], v[36:39], v[132:135], v[24:27]
    s_waitcnt vmcnt(10)
    buffer_load_dwordx4 a[56:59], v2, s[48:51], s69 offen offset:0 nt
    v_and_b32 v40, v16, v63
    v_and_b32 v41, v17, v63
    v_and_b32 v42, v18, v63
    v_and_b32 v43, v19, v63
    s_nop 1
    v_mfma_f32_16x16x32_bf16 v[20:23], v[40:43], v[128:131], v[20:23]
    v_mfma_f32_16x16x32_bf16 v[24:27], v[40:43], v[124:127], v[24:27]
    v_and_b32 v36, v16, v64
    v_and_b32 v37, v17, v64
    v_and_b32 v38, v18, v64
    v_and_b32 v39, v19, v64
    s_nop 1
    v_mfma_f32_16x16x32_bf16 v[20:23], v[36:39], v[120:123], v[20:23]
    v_mfma_f32_16x16x32_bf16 v[24:27], v[36:39], v[116:119], v[24:27]
    s_waitcnt vmcnt(10)
    buffer_load_dwordx4 a[60:63], v2, s[48:51], s69 offen offset:256 nt
    s_add_u32 s69, s69, 6144
    v_and_b32 v40, v16, v65
    v_and_b32 v41, v17, v65
    v_and_b32 v42, v18, v65
    v_and_b32 v43, v19, v65
    s_nop 1
    v_mfma_f32_16x16x32_bf16 v[20:23], v[40:43], v[112:115], v[20:23]
    v_mfma_f32_16x16x32_bf16 v[24:27], v[40:43], v[108:111], v[24:27]
    v_and_b32 v36, v16, v66
    v_and_b32 v37, v17, v66
    v_and_b32 v38, v18, v66
    v_and_b32 v39, v19, v66
    s_nop 1
    v_mfma_f32_16x16x32_bf16 v[20:23], v[36:39], v[104:107], v[20:23]
    v_mfma_f32_16x16x32_bf16 v[24:27], v[36:39], v[100:103], v[24:27]
    s_waitcnt vmcnt(10)
    buffer_load_dwordx4 a[64:67], v2, s[48:51], s69 offen offset:0 nt
    v_and_b32 v40, v16, v67
    v_and_b32 v41, v17, v67
    v_and_b32 v42, v18, v67
    v_and_b32 v43, v19, v67
    s_nop 1
    v_mfma_f32_16x16x32_bf16 v[20:23], v[40:43], a[0:3], v[20:23]
    v_mfma_f32_16x16x32_bf16 v[24:27], v[40:43], a[4:7], v[24:27]
    v_and_b32 v36, v16, v68
    v_and_b32 v37, v17, v68
    v_and_b32 v38, v18, v68
    v_and_b32 v39, v19, v68
    s_nop 1
    v_mfma_f32_16x16x32_bf16 v[20:23], v[36:39], a[8:11], v[20:23]
    v_mfma_f32_16x16x32_bf16 v[24:27], v[36:39], a[12:15], v[24:27]
    s_waitcnt vmcnt(10)
    buffer_load_dwordx4 a[68:71], v2, s[48:51], s69 offen offset:256 nt
    s_add_u32 s69, s69, 6144
    v_and_b32 v40, v16, v69
    v_and_b32 v41, v17, v69
    v_and_b32 v42, v18, v69
    v_and_b32 v43, v19, v69
    s_nop 1
    v_mfma_f32_16x16x32_bf16 v[20:23], v[40:43], a[16:19], v[20:23]
    v_mfma_f32_16x16x32_bf16 v[24:27], v[40:43], a[20:23], v[24:27]
    v_mov_b32 v9, 5120
    v_mov_b32 v10, 1
    ds_write_b32 v9, v10 offset:12
    s_waitcnt vmcnt(10)
    buffer_load_dwordx4 a[72:75], v2, s[48:51], s69 offen offset:0 nt
    v_and_b32 v36, v16, v70
    v_and_b32 v37, v17, v70
    v_and_b32 v38, v18, v70
    v_and_b32 v39, v19, v70
    s_nop 1
    v_mfma_f32_16x16x32_bf16 v[20:23], v[36:39], a[24:27], v[20:23]
    v_mfma_f32_16x16x32_bf16 v[24:27], v[36:39], a[28:31], v[24:27]
    s_waitcnt vmcnt(10)
    buffer_load_dwordx4 a[76:79], v2, s[48:51], s69 offen offset:256 nt
    s_add_u32 s69, s69, 6144
    s_waitcnt vmcnt(10)
    buffer_load_dwordx4 a[80:83], v2, s[48:51], s69 offen offset:0 nt
    v_and_b32 v40, v16, v71
    v_and_b32 v41, v17, v71
    v_and_b32 v42, v18, v71
    v_and_b32 v43, v19, v71
    s_nop 1
    v_mfma_f32_16x16x32_bf16 v[20:23], v[40:43], a[32:35], v[20:23]
    v_mfma_f32_16x16x32_bf16 v[24:27], v[40:43], a[36:39], v[24:27]
    s_waitcnt vmcnt(10)
    buffer_load_dwordx4 a[84:87], v2, s[48:51], s69 offen offset:256 nt
    s_add_u32 s69, s69, 6144
    s_waitcnt vmcnt(10)
    buffer_load_dwordx4 a[88:91], v2, s[48:51], s69 offen offset:0 nt
    v_and_b32 v36, v16, v72
    v_and_b32 v37, v17, v72
    v_and_b32 v38, v18, v72
    v_and_b32 v39, v19, v72
    s_nop 1
    v_mfma_f32_16x16x32_bf16 v[20:23], v[36:39], a[40:43], v[20:23]
    v_mfma_f32_16x16x32_bf16 v[24:27], v[36:39], a[44:47], v[24:27]
    s_waitcnt vmcnt(10)
    buffer_load_dwordx4 a[92:95], v2, s[48:51], s69 offen offset:256 nt
    s_add_u32 s69, s69, 6144
    s_waitcnt vmcnt(10)
    buffer_load_dwordx4 a[96:99], v2, s[48:51], s69 offen offset:0 nt
    v_and_b32 v40, v16, v73
    v_and_b32 v41, v17, v73
    v_and_b32 v42, v18, v73
    v_and_b32 v43, v19, v73
    s_nop 1
    v_mfma_f32_16x16x32_bf16 v[20:23], v[40:43], a[48:51], v[20:23]
    v_mfma_f32_16x16x32_bf16 v[24:27], v[40:43], a[52:55], v[24:27]
    s_waitcnt vmcnt(10)
    buffer_load_dwordx4 a[100:103], v2, s[48:51], s69 offen offset:256 nt
    s_add_u32 s69, s69, 6144
    s_waitcnt vmcnt(10)
    buffer_load_dwordx4 a[104:107], v2, s[48:51], s69 offen offset:0 nt
    v_and_b32 v36, v16, v74
    v_and_b32 v37, v17, v74
    v_and_b32 v38, v18, v74
    v_and_b32 v39, v19, v74
    s_nop 1
    v_mfma_f32_16x16x32_bf16 v[20:23], v[36:39], a[56:59], v[20:23]
    v_mfma_f32_16x16x32_bf16 v[24:27], v[36:39], a[60:63], v[24:27]
    s_waitcnt vmcnt(10)
    buffer_load_dwordx4 a[108:111], v2, s[48:51], s69 offen offset:256 nt
    s_add_u32 s69, s69, 6144
    s_waitcnt vmcnt(10)
    buffer_load_dwordx4 a[112:115], v2, s[48:51], s69 offen offset:0 nt
    v_and_b32 v40, v16, v75
    v_and_b32 v41, v17, v75
    v_and_b32 v42, v18, v75
    v_and_b32 v43, v19, v75
    s_nop 1
    v_mfma_f32_16x16x32_bf16 v[20:23], v[40:43], a[64:67], v[20:23]
    v_mfma_f32_16x16x32_bf16 v[24:27], v[40:43], a[68:71], v[24:27]
    s_waitcnt vmcnt(10)
    buffer_load_dwordx4 a[116:119], v2, s[48:51], s69 offen offset:256 nt
    s_add_u32 s69, s69, 6144
    s_waitcnt vmcnt(10)
    buffer_load_dwordx4 a[120:123], v2, s[48:51], s69 offen offset:0 nt
    v_and_b32 v36, v16, v76
    v_and_b32 v37, v17, v76
    v_and_b32 v38, v18, v76
    v_and_b32 v39, v19, v76
    s_nop 1
    v_mfma_f32_16x16x32_bf16 v[20:23], v[36:39], a[72:75], v[20:23]
    v_mfma_f32_16x16x32_bf16 v[24:27], v[36:39], a[76:79], v[24:27]
    s_waitcnt vmcnt(10)
    buffer_load_dwordx4 a[124:127], v2, s[48:51], s69 offen offset:256 nt
    s_add_u32 s69, s69, 6144
    s_waitcnt vmcnt(10)
    buffer_load_dwordx4 a[128:131], v2, s[48:51], s69 offen offset:0 nt
    v_and_b32 v40, v16, v77
    v_and_b32 v41, v17, v77
    v_and_b32 v42, v18, v77
    v_and_b32 v43, v19, v77
    s_nop 1
    v_mfma_f32_16x16x32_bf16 v[20:23], v[40:43], a[80:83], v[20:23]
    v_mfma_f32_16x16x32_bf16 v[24:27], v[40:43], a[84:87], v[24:27]
    s_mov_b32 s79, 1
    s_atomic_add s79, s[80:81], 0 glc
    s_waitcnt vmcnt(10)
    buffer_load_dwordx4 a[132:135], v2, s[48:51], s69 offen offset:256 nt
    s_add_u32 s69, s69, 6144
    s_waitcnt vmcnt(10)
    buffer_load_dwordx4 a[136:139], v2, s[48:51], s69 offen offset:0 nt
    v_and_b32 v36, v16, v78
    v_and_b32 v37, v17, v78
    v_and_b32 v38, v18, v78
    v_and_b32 v39, v19, v78
    s_nop 1
    v_mfma_f32_16x16x32_bf16 v[20:23], v[36:39], a[88:91], v[20:23]
    v_mfma_f32_16x16x32_bf16 v[24:27], v[36:39], a[92:95], v[24:27]
    s_waitcnt vmcnt(10)
    buffer_load_dwordx4 a[140:143], v2, s[48:51], s69 offen offset:256 nt
    s_add_u32 s69, s69, 6144
    s_waitcnt vmcnt(10)
    buffer_load_dwordx4 a[144:147], v2, s[48:51], s69 offen offset:0 nt
    v_and_b32 v40, v16, v79
    v_and_b32 v41, v17, v79
    v_and_b32 v42, v18, v79
    v_and_b32 v43, v19, v79
    s_nop 1
    v_mfma_f32_16x16x32_bf16 v[20:23], v[40:43], a[96:99], v[20:23]
    v_mfma_f32_16x16x32_bf16 v[24:27], v[40:43], a[100:103], v[24:27]
    s_waitcnt vmcnt(10)
    buffer_load_dwordx4 a[148:151], v2, s[48:51], s69 offen offset:256 nt
    s_add_u32 s69, s69, 6144
    s_waitcnt vmcnt(10)
    buffer_load_dwordx4 a[152:155], v2, s[48:51], s69 offen offset:0 nt
    v_and_b32 v36, v16, v80
    v_and_b32 v37, v17, v80
    v_and_b32 v38, v18, v80
    v_and_b32 v39, v19, v80
    s_nop 1
    v_mfma_f32_16x16x32_bf16 v[20:23], v[36:39], a[104:107], v[20:23]
    v_mfma_f32_16x16x32_bf16 v[24:27], v[36:39], a[108:111], v[24:27]
    s_waitcnt vmcnt(10)
    buffer_load_dwordx4 a[156:159], v2, s[48:51], s69 offen offset:256 nt
    s_add_u32 s69, s69, 6144
    s_waitcnt lgkmcnt(0)
    s_sub_u32 s12, s79, 1048576
    s_cmp_ge_u32 s12, 96
    s_cbranch_scc1 L_drain0
    s_mov_b32 s79, 1
    s_atomic_add s79, s[80:81], 0 glc
    s_lshl_b32 s76, s12, 7
    s_add_u32 s76, s76, s78
    s_mul_i32 s66, s12, 2731
    s_lshr_b32 s66, s66, 16
    s_mul_i32 s65, s66, 24
    s_sub_u32 s12, s12, s65
    s_mul_i32 s65, s12, 43
    s_lshr_b32 s65, s65, 7
    s_mul_i32 s66, s66, 12
    s_add_u32 s66, s66, s12
    s_mul_i32 s12, s65, 125
    s_add_u32 s66, s66, s12
    s_lshl_b32 s74, s66, 11
    s_waitcnt vmcnt(10)
    buffer_load_dwordx4 v[244:247], v95, s[40:43], s76 offen sc1
    v_and_b32 v40, v16, v81
    v_and_b32 v41, v17, v81
    v_and_b32 v42, v18, v81
    v_and_b32 v43, v19, v81
    s_nop 1
    v_mfma_f32_16x16x32_bf16 v[20:23], v[40:43], a[112:115], v[20:23]
    v_mfma_f32_16x16x32_bf16 v[24:27], v[40:43], a[116:119], v[24:27]
    s_waitcnt vmcnt(10)
    buffer_load_dwordx4 a[160:163], v2, s[48:51], s74 offen offset:0 nt
    s_waitcnt vmcnt(10)
    buffer_load_dwordx4 a[164:167], v2, s[48:51], s74 offen offset:256 nt
    s_add_u32 s74, s74, 6144
    v_and_b32 v36, v16, v82
    v_and_b32 v37, v17, v82
    v_and_b32 v38, v18, v82
    v_and_b32 v39, v19, v82
    s_nop 1
    v_mfma_f32_16x16x32_bf16 v[20:23], v[36:39], a[120:123], v[20:23]
    v_mfma_f32_16x16x32_bf16 v[24:27], v[36:39], a[124:127], v[24:27]
    s_waitcnt vmcnt(10)
    buffer_load_dwordx4 a[168:171], v2, s[48:51], s74 offen offset:0 nt
    s_waitcnt vmcnt(10)
    buffer_load_dwordx4 a[172:175], v2, s[48:51], s74 offen offset:256 nt
    s_add_u32 s74, s74, 6144
    v_and_b32 v40, v16, v83
    v_and_b32 v41, v17, v83
    v_and_b32 v42, v18, v83
    v_and_b32 v43, v19, v83
    s_nop 1
    v_mfma_f32_16x16x32_bf16 v[20:23], v[40:43], a[128:131], v[20:23]
    v_mfma_f32_16x16x32_bf16 v[24:27], v[40:43], a[132:135], v[24:27]
    s_waitcnt vmcnt(10)
    buffer_load_dwordx4 a[176:179], v2, s[48:51], s74 offen offset:0 nt
    s_waitcnt vmcnt(10)
    buffer_load_dwordx4 a[180:183], v2, s[48:51], s74 offen offset:256 nt
    s_add_u32 s74, s74, 6144
    v_and_b32 v36, v16, v84
    v_and_b32 v37, v17, v84
    v_and_b32 v38, v18, v84
    v_and_b32 v39, v19, v84
    s_nop 1
    v_mfma_f32_16x16x32_bf16 v[20:23], v[36:39], a[136:139], v[20:23]
    v_mfma_f32_16x16x32_bf16 v[24:27], v[36:39], a[140:143], v[24:27]
    s_waitcnt vmcnt(10)
    buffer_load_dwordx4 a[184:187], v2, s[48:51], s74 offen offset:0 nt
    s_waitcnt vmcnt(10)
    buffer_load_dwordx4 a[188:191], v2, s[48:51], s74 offen offset:256 nt
    v_and_b32 v40, v16, v85
    v_and_b32 v41, v17, v85
    v_and_b32 v42, v18, v85
    v_and_b32 v43, v19, v85
    s_nop 1
    v_mfma_f32_16x16x32_bf16 v[20:23], v[40:43], a[144:147], v[20:23]
    v_mfma_f32_16x16x32_bf16 v[24:27], v[40:43], a[148:151], v[24:27]
    s_waitcnt lgkmcnt(0)
    s_sub_u32 s12, s79, 1048576
    s_cmp_ge_u32 s12, 96
    s_cbranch_scc1 L_drain1
    s_mov_b32 s79, 1
    s_atomic_add s79, s[80:81], 0 glc
    s_lshl_b32 s77, s12, 7
    s_add_u32 s77, s77, s78
    s_mul_i32 s66, s12, 2731
    s_lshr_b32 s66, s66, 16
    s_mul_i32 s65, s66, 24
    s_sub_u32 s12, s12, s65
    s_mul_i32 s65, s12, 43
    s_lshr_b32 s65, s65, 7
    s_mul_i32 s66, s66, 12
    s_add_u32 s66, s66, s12
    s_mul_i32 s12, s65, 125
    s_add_u32 s66, s66, s12
    s_lshl_b32 s75, s66, 11
    s_waitcnt vmcnt(10)
    buffer_load_dwordx4 v[248:251], v95, s[40:43], s77 offen sc1
    s_waitcnt vmcnt(10)
    buffer_load_dwordx4 a[192:195], v2, s[48:51], s75 offen offset:0 nt
    v_and_b32 v36, v16, v86
    v_and_b32 v37, v17, v86
    v_and_b32 v38, v18, v86
    v_and_b32 v39, v19, v86
    s_nop 1
    v_mfma_f32_16x16x32_bf16 v[20:23], v[36:39], a[152:155], v[20:23]
    v_mfma_f32_16x16x32_bf16 v[24:27], v[36:39], a[156:159], v[24:27]
    s_waitcnt vmcnt(10)
    buffer_load_dwordx4 a[196:199], v2, s[48:51], s75 offen offset:256 nt
    s_add_u32 s75, s75, 6144
    s_mov_b32 s11, s63
L_poll1:
    v_xor_b32 v9, v97, v245
    v_xor_b32 v10, v97, v247
    v_or_b32 v9, v9, v10
    v_cmp_ne_u32 vcc, 0, v9
    s_nop 1
    s_cbranch_vccz L_done1
    s_sub_u32 s11, s11, 1
    s_cbranch_scc1 L_done1
    s_sleep 8
    buffer_load_dwordx4 v[244:247], v95, s[40:43], s76 offen sc1
    s_waitcnt vmcnt(0)
    s_branch L_poll1
L_done1:
    v_lshlrev_b32 v252, 16, v244
    v_and_b32 v253, 0xffff0000, v244
    v_lshlrev_b32 v254, 16, v246
    v_and_b32 v255, 0xffff0000, v246
    v_max3_f32 v9, v252, v253, v254
    v_max_f32 v9, v9, v255
    v_cmp_gt_f32 vcc, v9, v96
    s_nop 1
    s_cbranch_vccz L_skip6
    v_mov_b32 v10, v9
    s_nop 1
    v_permlane16_swap_b32 v9, v10
    v_max_f32 v9, v9, v10
    v_mov_b32 v10, v9
    s_nop 1
    v_permlane32_swap_b32 v9, v10
    v_max_f32 v9, v9, v10
    v_max_f32 v9, v9, v96
    v_sub_f32 v10, v96, v9
    v_mul_f32 v10, s67, v10
    v_exp_f32 v10, v10
    v_mov_b32 v96, v9
    v_readlane_b32 s65, v10, 0
    v_readlane_b32 s66, v10, 8
    s_nop 1
    v_mov_b32 v10, s66
    s_mov_b32 exec_hi, 0
    v_mov_b32 v10, s65
    s_mov_b32 exec_hi, s1
    s_nop 7
    v_mul_f32 v20, v10, v20
    v_mul_f32 v21, v10, v21
    v_mul_f32 v22, v10, v22
    v_mul_f32 v23, v10, v23
    v_mul_f32 v24, v10, v24
    v_mul_f32 v25, v10, v25
    v_mul_f32 v26, v10, v26
    v_mul_f32 v27, v10, v27
L_skip6:
    v_sub_f32 v252, v252, v96
    v_sub_f32 v253, v253, v96
    v_sub_f32 v254, v254, v96
    v_sub_f32 v255, v255, v96
    v_mul_f32 v252, s67, v252
    v_mul_f32 v253, s67, v253
    v_mul_f32 v254, s67, v254
    v_mul_f32 v255, s67, v255
    v_exp_f32 v252, v252
    v_exp_f32 v253, v253
    v_exp_f32 v254, v254
    v_exp_f32 v255, v255
    v_cvt_pk_bf16_f32 v252, v252, v252
    v_cvt_pk_bf16_f32 v253, v253, v253
    v_cvt_pk_bf16_f32 v254, v254, v254
    v_cvt_pk_bf16_f32 v255, v255, v255
    s_waitcnt vmcnt(10)
    buffer_load_dwordx4 a[200:203], v2, s[48:51], s75 offen offset:0 nt
    s_waitcnt vmcnt(10)
    buffer_load_dwordx4 a[204:207], v2, s[48:51], s75 offen offset:256 nt
    s_add_u32 s75, s75, 6144
    v_and_b32 v36, v16, v252
    v_and_b32 v37, v17, v252
    v_and_b32 v38, v18, v252
    v_and_b32 v39, v19, v252
    s_nop 1
    v_mfma_f32_16x16x32_bf16 v[20:23], v[36:39], a[160:163], v[20:23]
    v_mfma_f32_16x16x32_bf16 v[24:27], v[36:39], a[164:167], v[24:27]
    s_waitcnt vmcnt(10)
    buffer_load_dwordx4 a[208:211], v2, s[48:51], s75 offen offset:0 nt
    s_waitcnt vmcnt(10)
    buffer_load_dwordx4 a[212:215], v2, s[48:51], s75 offen offset:256 nt
    s_add_u32 s75, s75, 6144
    v_and_b32 v40, v16, v253
    v_and_b32 v41, v17, v253
    v_and_b32 v42, v18, v253
    v_and_b32 v43, v19, v253
    s_nop 1
    v_mfma_f32_16x16x32_bf16 v[20:23], v[40:43], a[168:171], v[20:23]
    v_mfma_f32_16x16x32_bf16 v[24:27], v[40:43], a[172:175], v[24:27]
    s_waitcnt vmcnt(10)
    buffer_load_dwordx4 a[216:219], v2, s[48:51], s75 offen offset:0 nt
    s_waitcnt vmcnt(10)
    buffer_load_dwordx4 a[220:223], v2, s[48:51], s75 offen offset:256 nt
    v_and_b32 v36, v16, v254
    v_and_b32 v37, v17, v254
    v_and_b32 v38, v18, v254
    v_and_b32 v39, v19, v254
    s_nop 1
    v_mfma_f32_16x16x32_bf16 v[20:23], v[36:39], a[176:179], v[20:23]
    v_mfma_f32_16x16x32_bf16 v[24:27], v[36:39], a[180:183], v[24:27]
L_pool:
    s_waitcnt lgkmcnt(0)
    s_sub_u32 s12, s79, 1048576
    s_cmp_ge_u32 s12, 96
    s_cbranch_scc1 L_drain2
    s_mov_b32 s79, 1
    s_atomic_add s79, s[80:81], 0 glc
    s_lshl_b32 s76, s12, 7
    s_add_u32 s76, s76, s78
    s_mul_i32 s66, s12, 2731
    s_lshr_b32 s66, s66, 16
    s_mul_i32 s65, s66, 24
    s_sub_u32 s12, s12, s65
    s_mul_i32 s65, s12, 43
    s_lshr_b32 s65, s65, 7
    s_mul_i32 s66, s66, 12
    s_add_u32 s66, s66, s12
    s_mul_i32 s12, s65, 125
    s_add_u32 s66, s66, s12
    s_lshl_b32 s74, s66, 11
    s_waitcnt vmcnt(10)
    buffer_load_dwordx4 v[244:247], v95, s[40:43], s76 offen sc1
    s_waitcnt vmcnt(10)
    buffer_load_dwordx4 a[160:163], v2, s[48:51], s74 offen offset:0 nt
    v_and_b32 v40, v16, v255
    v_and_b32 v41, v17, v255
    v_and_b32 v42, v18, v255
    v_and_b32 v43, v19, v255
    s_nop 1
    v_mfma_f32_16x16x32_bf16 v[20:23], v[40:43], a[184:187], v[20:23]
    v_mfma_f32_16x16x32_bf16 v[24:27], v[40:43], a[188:191], v[24:27]
    s_waitcnt vmcnt(10)
    buffer_load_dwordx4 a[164:167], v2, s[48:51], s74 offen offset:256 nt
    s_add_u32 s74, s74, 6144
    s_mov_b32 s11, s63
L_poll2:
    v_xor_b32 v9, v97, v249
    v_xor_b32 v10, v97, v251
    v_or_b32 v9, v9, v10
    v_cmp_ne_u32 vcc, 0, v9
    s_nop 1
    s_cbranch_vccz L_done2
    s_sub_u32 s11, s11, 1
    s_cbranch_scc1 L_done2
    s_sleep 8
    buffer_load_dwordx4 v[248:251], v95, s[40:43], s77 offen sc1
    s_waitcnt vmcnt(0)
    s_branch L_poll2
L_done2:
    v_lshlrev_b32 v252, 16, v248
    v_and_b32 v253, 0xffff0000, v248
    v_lshlrev_b32 v254, 16, v250
    v_and_b32 v255, 0xffff0000, v250
    v_max3_f32 v9, v252, v253, v254
    v_max_f32 v9, v9, v255
    v_cmp_gt_f32 vcc, v9, v96
    s_nop 1
    s_cbranch_vccz L_skip7
    v_mov_b32 v10, v9
    s_nop 1
    v_permlane16_swap_b32 v9, v10
    v_max_f32 v9, v9, v10
    v_mov_b32 v10, v9
    s_nop 1
    v_permlane32_swap_b32 v9, v10
    v_max_f32 v9, v9, v10
    v_max_f32 v9, v9, v96
    v_sub_f32 v10, v96, v9
    v_mul_f32 v10, s67, v10
    v_exp_f32 v10, v10
    v_mov_b32 v96, v9
    v_readlane_b32 s65, v10, 0
    v_readlane_b32 s66, v10, 8
    s_nop 1
    v_mov_b32 v10, s66
    s_mov_b32 exec_hi, 0
    v_mov_b32 v10, s65
    s_mov_b32 exec_hi, s1
    s_nop 7
    v_mul_f32 v20, v10, v20
    v_mul_f32 v21, v10, v21
    v_mul_f32 v22, v10, v22
    v_mul_f32 v23, v10, v23
    v_mul_f32 v24, v10, v24
    v_mul_f32 v25, v10, v25
    v_mul_f32 v26, v10, v26
    v_mul_f32 v27, v10, v27
L_skip7:
    v_sub_f32 v252, v252, v96
    v_sub_f32 v253, v253, v96
    v_sub_f32 v254, v254, v96
    v_sub_f32 v255, v255, v96
    v_mul_f32 v252, s67, v252
    v_mul_f32 v253, s67, v253
    v_mul_f32 v254, s67, v254
    v_mul_f32 v255, s67, v255
    v_exp_f32 v252, v252
    v_exp_f32 v253, v253
    v_exp_f32 v254, v254
    v_exp_f32 v255, v255
    v_cvt_pk_bf16_f32 v252, v252, v252
    v_cvt_pk_bf16_f32 v253, v253, v253
    v_cvt_pk_bf16_f32 v254, v254, v254
    v_cvt_pk_bf16_f32 v255, v255, v255
    s_waitcnt vmcnt(10)
    buffer_load_dwordx4 a[168:171], v2, s[48:51], s74 offen offset:0 nt
    s_waitcnt vmcnt(10)
    buffer_load_dwordx4 a[172:175], v2, s[48:51], s74 offen offset:256 nt
    s_add_u32 s74, s74, 6144
    v_and_b32 v36, v16, v252
    v_and_b32 v37, v17, v252
    v_and_b32 v38, v18, v252
    v_and_b32 v39, v19, v252
    s_nop 1
    v_mfma_f32_16x16x32_bf16 v[20:23], v[36:39], a[192:195], v[20:23]
    v_mfma_f32_16x16x32_bf16 v[24:27], v[36:39], a[196:199], v[24:27]
    s_waitcnt vmcnt(10)
    buffer_load_dwordx4 a[176:179], v2, s[48:51], s74 offen offset:0 nt
    s_waitcnt vmcnt(10)
    buffer_load_dwordx4 a[180:183], v2, s[48:51], s74 offen offset:256 nt
    s_add_u32 s74, s74, 6144
    v_and_b32 v40, v16, v253
    v_and_b32 v41, v17, v253
    v_and_b32 v42, v18, v253
    v_and_b32 v43, v19, v253
    s_nop 1
    v_mfma_f32_16x16x32_bf16 v[20:23], v[40:43], a[200:203], v[20:23]
    v_mfma_f32_16x16x32_bf16 v[24:27], v[40:43], a[204:207], v[24:27]
    s_waitcnt vmcnt(10)
    buffer_load_dwordx4 a[184:187], v2, s[48:51], s74 offen offset:0 nt
    s_waitcnt vmcnt(10)
    buffer_load_dwordx4 a[188:191], v2, s[48:51], s74 offen offset:256 nt
    v_and_b32 v36, v16, v254
    v_and_b32 v37, v17, v254
    v_and_b32 v38, v18, v254
    v_and_b32 v39, v19, v254
    s_nop 1
    v_mfma_f32_16x16x32_bf16 v[20:23], v[36:39], a[208:211], v[20:23]
    v_mfma_f32_16x16x32_bf16 v[24:27], v[36:39], a[212:215], v[24:27]
    s_waitcnt lgkmcnt(0)
    s_sub_u32 s12, s79, 1048576
    s_cmp_ge_u32 s12, 96
    s_cbranch_scc1 L_drain3
    s_mov_b32 s79, 1
    s_atomic_add s79, s[80:81], 0 glc
    s_lshl_b32 s77, s12, 7
    s_add_u32 s77, s77, s78
    s_mul_i32 s66, s12, 2731
    s_lshr_b32 s66, s66, 16
    s_mul_i32 s65, s66, 24
    s_sub_u32 s12, s12, s65
    s_mul_i32 s65, s12, 43
    s_lshr_b32 s65, s65, 7
    s_mul_i32 s66, s66, 12
    s_add_u32 s66, s66, s12
    s_mul_i32 s12, s65, 125
    s_add_u32 s66, s66, s12
    s_lshl_b32 s75, s66, 11
    s_waitcnt vmcnt(10)
    buffer_load_dwordx4 v[248:251], v95, s[40:43], s77 offen sc1
    s_waitcnt vmcnt(10)
    buffer_load_dwordx4 a[192:195], v2, s[48:51], s75 offen offset:0 nt
    v_and_b32 v40, v16, v255
    v_and_b32 v41, v17, v255
    v_and_b32 v42, v18, v255
    v_and_b32 v43, v19, v255
    s_nop 1
    v_mfma_f32_16x16x32_bf16 v[20:23], v[40:43], a[216:219], v[20:23]
    v_mfma_f32_16x16x32_bf16 v[24:27], v[40:43], a[220:223], v[24:27]
    s_waitcnt vmcnt(10)
    buffer_load_dwordx4 a[196:199], v2, s[48:51], s75 offen offset:256 nt
    s_add_u32 s75, s75, 6144
    s_mov_b32 s11, s63
L_poll3:
    v_xor_b32 v9, v97, v245
    v_xor_b32 v10, v97, v247
    v_or_b32 v9, v9, v10
    v_cmp_ne_u32 vcc, 0, v9
    s_nop 1
    s_cbranch_vccz L_done3
    s_sub_u32 s11, s11, 1
    s_cbranch_scc1 L_done3
    s_sleep 8
    buffer_load_dwordx4 v[244:247], v95, s[40:43], s76 offen sc1
    s_waitcnt vmcnt(0)
    s_branch L_poll3
L_done3:
    v_lshlrev_b32 v252, 16, v244
    v_and_b32 v253, 0xffff0000, v244
    v_lshlrev_b32 v254, 16, v246
    v_and_b32 v255, 0xffff0000, v246
    v_max3_f32 v9, v252, v253, v254
    v_max_f32 v9, v9, v255
    v_cmp_gt_f32 vcc, v9, v96
    s_nop 1
    s_cbranch_vccz L_skip8
    v_mov_b32 v10, v9
    s_nop 1
    v_permlane16_swap_b32 v9, v10
    v_max_f32 v9, v9, v10
    v_mov_b32 v10, v9
    s_nop 1
    v_permlane32_swap_b32 v9, v10
    v_max_f32 v9, v9, v10
    v_max_f32 v9, v9, v96
    v_sub_f32 v10, v96, v9
    v_mul_f32 v10, s67, v10
    v_exp_f32 v10, v10
    v_mov_b32 v96, v9
    v_readlane_b32 s65, v10, 0
    v_readlane_b32 s66, v10, 8
    s_nop 1
    v_mov_b32 v10, s66
    s_mov_b32 exec_hi, 0
    v_mov_b32 v10, s65
    s_mov_b32 exec_hi, s1
    s_nop 7
    v_mul_f32 v20, v10, v20
    v_mul_f32 v21, v10, v21
    v_mul_f32 v22, v10, v22
    v_mul_f32 v23, v10, v23
    v_mul_f32 v24, v10, v24
    v_mul_f32 v25, v10, v25
    v_mul_f32 v26, v10, v26
    v_mul_f32 v27, v10, v27
L_skip8:
    v_sub_f32 v252, v252, v96
    v_sub_f32 v253, v253, v96
    v_sub_f32 v254, v254, v96
    v_sub_f32 v255, v255, v96
    v_mul_f32 v252, s67, v252
    v_mul_f32 v253, s67, v253
    v_mul_f32 v254, s67, v254
    v_mul_f32 v255, s67, v255
    v_exp_f32 v252, v252
    v_exp_f32 v253, v253
    v_exp_f32 v254, v254
    v_exp_f32 v255, v255
    v_cvt_pk_bf16_f32 v252, v252, v252
    v_cvt_pk_bf16_f32 v253, v253, v253
    v_cvt_pk_bf16_f32 v254, v254, v254
    v_cvt_pk_bf16_f32 v255, v255, v255
    s_waitcnt vmcnt(10)
    buffer_load_dwordx4 a[200:203], v2, s[48:51], s75 offen offset:0 nt
    s_waitcnt vmcnt(10)
    buffer_load_dwordx4 a[204:207], v2, s[48:51], s75 offen offset:256 nt
    s_add_u32 s75, s75, 6144
    v_and_b32 v36, v16, v252
    v_and_b32 v37, v17, v252
    v_and_b32 v38, v18, v252
    v_and_b32 v39, v19, v252
    s_nop 1
    v_mfma_f32_16x16x32_bf16 v[20:23], v[36:39], a[160:163], v[20:23]
    v_mfma_f32_16x16x32_bf16 v[24:27], v[36:39], a[164:167], v[24:27]
    s_waitcnt vmcnt(10)
    buffer_load_dwordx4 a[208:211], v2, s[48:51], s75 offen offset:0 nt
    s_waitcnt vmcnt(10)
    buffer_load_dwordx4 a[212:215], v2, s[48:51], s75 offen offset:256 nt
    s_add_u32 s75, s75, 6144
    v_and_b32 v40, v16, v253
    v_and_b32 v41, v17, v253
    v_and_b32 v42, v18, v253
    v_and_b32 v43, v19, v253
    s_nop 1
    v_mfma_f32_16x16x32_bf16 v[20:23], v[40:43], a[168:171], v[20:23]
    v_mfma_f32_16x16x32_bf16 v[24:27], v[40:43], a[172:175], v[24:27]
    s_waitcnt vmcnt(10)
    buffer_load_dwordx4 a[216:219], v2, s[48:51], s75 offen offset:0 nt
    s_waitcnt vmcnt(10)
    buffer_load_dwordx4 a[220:223], v2, s[48:51], s75 offen offset:256 nt
    v_and_b32 v36, v16, v254
    v_and_b32 v37, v17, v254
    v_and_b32 v38, v18, v254
    v_and_b32 v39, v19, v254
    s_nop 1
    v_mfma_f32_16x16x32_bf16 v[20:23], v[36:39], a[176:179], v[20:23]
    v_mfma_f32_16x16x32_bf16 v[24:27], v[36:39], a[180:183], v[24:27]
    s_branch L_pool
L_drain1:
    s_waitcnt vmcnt(10)
    s_waitcnt vmcnt(9)
    v_and_b32 v36, v16, v86
    v_and_b32 v37, v17, v86
    v_and_b32 v38, v18, v86
    v_and_b32 v39, v19, v86
    s_nop 1
    v_mfma_f32_16x16x32_bf16 v[20:23], v[36:39], a[152:155], v[20:23]
    v_mfma_f32_16x16x32_bf16 v[24:27], v[36:39], a[156:159], v[24:27]
    s_waitcnt vmcnt(8)
    s_mov_b32 s11, s63
L_poll4:
    v_xor_b32 v9, v97, v245
    v_xor_b32 v10, v97, v247
    v_or_b32 v9, v9, v10
    v_cmp_ne_u32 vcc, 0, v9
    s_nop 1
    s_cbranch_vccz L_done4
    s_sub_u32 s11, s11, 1
    s_cbranch_scc1 L_done4
    s_sleep 8
    buffer_load_dwordx4 v[244:247], v95, s[40:43], s76 offen sc1
    s_waitcnt vmcnt(0)
    s_branch L_poll4
L_done4:
    v_lshlrev_b32 v252, 16, v244
    v_and_b32 v253, 0xffff0000, v244
    v_lshlrev_b32 v254, 16, v246
    v_and_b32 v255, 0xffff0000, v246
    v_max3_f32 v9, v252, v253, v254
    v_max_f32 v9, v9, v255
    v_cmp_gt_f32 vcc, v9, v96
    s_nop 1
    s_cbranch_vccz L_skip9
    v_mov_b32 v10, v9
    s_nop 1
    v_permlane16_swap_b32 v9, v10
    v_max_f32 v9, v9, v10
    v_mov_b32 v10, v9
    s_nop 1
    v_permlane32_swap_b32 v9, v10
    v_max_f32 v9, v9, v10
    v_max_f32 v9, v9, v96
    v_sub_f32 v10, v96, v9
    v_mul_f32 v10, s67, v10
    v_exp_f32 v10, v10
    v_mov_b32 v96, v9
    v_readlane_b32 s65, v10, 0
    v_readlane_b32 s66, v10, 8
    s_nop 1
    v_mov_b32 v10, s66
    s_mov_b32 exec_hi, 0
    v_mov_b32 v10, s65
    s_mov_b32 exec_hi, s1
    s_nop 7
    v_mul_f32 v20, v10, v20
    v_mul_f32 v21, v10, v21
    v_mul_f32 v22, v10, v22
    v_mul_f32 v23, v10, v23
    v_mul_f32 v24, v10, v24
    v_mul_f32 v25, v10, v25
    v_mul_f32 v26, v10, v26
    v_mul_f32 v27, v10, v27
L_skip9:
    v_sub_f32 v252, v252, v96
    v_sub_f32 v253, v253, v96
    v_sub_f32 v254, v254, v96
    v_sub_f32 v255, v255, v96
    v_mul_f32 v252, s67, v252
    v_mul_f32 v253, s67, v253
    v_mul_f32 v254, s67, v254
    v_mul_f32 v255, s67, v255
    v_exp_f32 v252, v252
    v_exp_f32 v253, v253
    v_exp_f32 v254, v254
    v_exp_f32 v255, v255
    v_cvt_pk_bf16_f32 v252, v252, v252
    v_cvt_pk_bf16_f32 v253, v253, v253
    v_cvt_pk_bf16_f32 v254, v254, v254
    v_cvt_pk_bf16_f32 v255, v255, v255
    v_readlane_b32 s65, v96, 0
    v_readlane_b32 s66, v96, 8
    v_mov_b32 v9, 5184
L_mlw1:
    ds_read_b32 v10, v9 offset:16
    s_waitcnt lgkmcnt(0)
    v_cmp_eq_u32 vcc, 0, v10
    s_nop 1
    s_cbranch_vccz L_mlw1_ok
    s_sleep 1
    s_branch L_mlw1
L_mlw1_ok:
    ds_read2_b32 v[12:13], v8 offset0:0 offset1:2
    v_mov_b32 v11, s66
    s_mov_b32 exec_hi, 0
    v_mov_b32 v11, s65
    s_mov_b32 exec_hi, s1
    s_waitcnt lgkmcnt(0)
    v_sub_f32 v11, v11, v12
    v_mul_f32 v11, s67, v11
    v_exp_f32 v11, v11
    s_nop 0
    v_mul_f32 v11, v11, v13
    s_waitcnt vmcnt(7)
    s_waitcnt vmcnt(6)
    v_and_b32 v36, v16, v252
    v_and_b32 v37, v17, v252
    v_and_b32 v38, v18, v252
    v_and_b32 v39, v19, v252
    s_nop 1
    v_mfma_f32_16x16x32_bf16 v[20:23], v[36:39], a[160:163], v[20:23]
    v_mfma_f32_16x16x32_bf16 v[24:27], v[36:39], a[164:167], v[24:27]
    s_waitcnt vmcnt(5)
    buffer_load_dwordx4 a[224:227], v3, s[52:55], s70 offen offset:0
    s_waitcnt vmcnt(5)
    buffer_load_dwordx4 a[228:231], v3, s[52:55], s70 offen offset:128
    s_add_u32 s70, s70, 896
    v_and_b32 v40, v16, v253
    v_and_b32 v41, v17, v253
    v_and_b32 v42, v18, v253
    v_and_b32 v43, v19, v253
    s_nop 1
    v_mfma_f32_16x16x32_bf16 v[20:23], v[40:43], a[168:171], v[20:23]
    v_mfma_f32_16x16x32_bf16 v[24:27], v[40:43], a[172:175], v[24:27]
    s_waitcnt vmcnt(5)
    buffer_load_dwordx4 a[232:235], v3, s[52:55], s70 offen offset:0
    s_waitcnt vmcnt(5)
    buffer_load_dwordx4 a[236:239], v3, s[52:55], s70 offen offset:128
    s_add_u32 s70, s70, 896
    v_and_b32 v36, v16, v254
    v_and_b32 v37, v17, v254
    v_and_b32 v38, v18, v254
    v_and_b32 v39, v19, v254
    s_nop 1
    v_mfma_f32_16x16x32_bf16 v[20:23], v[36:39], a[176:179], v[20:23]
    v_mfma_f32_16x16x32_bf16 v[24:27], v[36:39], a[180:183], v[24:27]
    s_waitcnt vmcnt(5)
    buffer_load_dwordx4 a[240:243], v3, s[52:55], s70 offen offset:0
    s_waitcnt vmcnt(5)
    buffer_load_dwordx4 a[244:247], v3, s[52:55], s70 offen offset:128
    s_add_u32 s70, s70, 896
    v_and_b32 v40, v16, v255
    v_and_b32 v41, v17, v255
    v_and_b32 v42, v18, v255
    v_and_b32 v43, v19, v255
    s_nop 1
    v_mfma_f32_16x16x32_bf16 v[20:23], v[40:43], a[184:187], v[20:23]
    v_mfma_f32_16x16x32_bf16 v[24:27], v[40:43], a[188:191], v[24:27]
    s_branch L_vdone
L_drain2:
    s_waitcnt vmcnt(10)
    s_waitcnt vmcnt(9)
    v_and_b32 v40, v16, v255
    v_and_b32 v41, v17, v255
    v_and_b32 v42, v18, v255
    v_and_b32 v43, v19, v255
    s_nop 1
    v_mfma_f32_16x16x32_bf16 v[20:23], v[40:43], a[184:187], v[20:23]
    v_mfma_f32_16x16x32_bf16 v[24:27], v[40:43], a[188:191], v[24:27]
    s_waitcnt vmcnt(8)
    s_mov_b32 s11, s63
L_poll5:
    v_xor_b32 v9, v97, v249
    v_xor_b32 v10, v97, v251
    v_or_b32 v9, v9, v10
    v_cmp_ne_u32 vcc, 0, v9
    s_nop 1
    s_cbranch_vccz L_done5
    s_sub_u32 s11, s11, 1
    s_cbranch_scc1 L_done5
    s_sleep 8
    buffer_load_dwordx4 v[248:251], v95, s[40:43], s77 offen sc1
    s_waitcnt vmcnt(0)
    s_branch L_poll5
L_done5:
    v_lshlrev_b32 v252, 16, v248
    v_and_b32 v253, 0xffff0000, v248
    v_lshlrev_b32 v254, 16, v250
    v_and_b32 v255, 0xffff0000, v250
    v_max3_f32 v9, v252, v253, v254
    v_max_f32 v9, v9, v255
    v_cmp_gt_f32 vcc, v9, v96
    s_nop 1
    s_cbranch_vccz L_skip10
    v_mov_b32 v10, v9
    s_nop 1
    v_permlane16_swap_b32 v9, v10
    v_max_f32 v9, v9, v10
    v_mov_b32 v10, v9
    s_nop 1
    v_permlane32_swap_b32 v9, v10
    v_max_f32 v9, v9, v10
    v_max_f32 v9, v9, v96
    v_sub_f32 v10, v96, v9
    v_mul_f32 v10, s67, v10
    v_exp_f32 v10, v10
    v_mov_b32 v96, v9
    v_readlane_b32 s65, v10, 0
    v_readlane_b32 s66, v10, 8
    s_nop 1
    v_mov_b32 v10, s66
    s_mov_b32 exec_hi, 0
    v_mov_b32 v10, s65
    s_mov_b32 exec_hi, s1
    s_nop 7
    v_mul_f32 v20, v10, v20
    v_mul_f32 v21, v10, v21
    v_mul_f32 v22, v10, v22
    v_mul_f32 v23, v10, v23
    v_mul_f32 v24, v10, v24
    v_mul_f32 v25, v10, v25
    v_mul_f32 v26, v10, v26
    v_mul_f32 v27, v10, v27
L_skip10:
    v_sub_f32 v252, v252, v96
    v_sub_f32 v253, v253, v96
    v_sub_f32 v254, v254, v96
    v_sub_f32 v255, v255, v96
    v_mul_f32 v252, s67, v252
    v_mul_f32 v253, s67, v253
    v_mul_f32 v254, s67, v254
    v_mul_f32 v255, s67, v255
    v_exp_f32 v252, v252
    v_exp_f32 v253, v253
    v_exp_f32 v254, v254
    v_exp_f32 v255, v255
    v_cvt_pk_bf16_f32 v252, v252, v252
    v_cvt_pk_bf16_f32 v253, v253, v253
    v_cvt_pk_bf16_f32 v254, v254, v254
    v_cvt_pk_bf16_f32 v255, v255, v255
    v_readlane_b32 s65, v96, 0
    v_readlane_b32 s66, v96, 8
    v_mov_b32 v9, 5184
L_mlw2:
    ds_read_b32 v10, v9 offset:16
    s_waitcnt lgkmcnt(0)
    v_cmp_eq_u32 vcc, 0, v10
    s_nop 1
    s_cbranch_vccz L_mlw2_ok
    s_sleep 1
    s_branch L_mlw2
L_mlw2_ok:
    ds_read2_b32 v[12:13], v8 offset0:0 offset1:2
    v_mov_b32 v11, s66
    s_mov_b32 exec_hi, 0
    v_mov_b32 v11, s65
    s_mov_b32 exec_hi, s1
    s_waitcnt lgkmcnt(0)
    v_sub_f32 v11, v11, v12
    v_mul_f32 v11, s67, v11
    v_exp_f32 v11, v11
    s_nop 0
    v_mul_f32 v11, v11, v13
    s_waitcnt vmcnt(7)
    s_waitcnt vmcnt(6)
    v_and_b32 v36, v16, v252
    v_and_b32 v37, v17, v252
    v_and_b32 v38, v18, v252
    v_and_b32 v39, v19, v252
    s_nop 1
    v_mfma_f32_16x16x32_bf16 v[20:23], v[36:39], a[192:195], v[20:23]
    v_mfma_f32_16x16x32_bf16 v[24:27], v[36:39], a[196:199], v[24:27]
    s_waitcnt vmcnt(5)
    buffer_load_dwordx4 a[224:227], v3, s[52:55], s70 offen offset:0
    s_waitcnt vmcnt(5)
    buffer_load_dwordx4 a[228:231], v3, s[52:55], s70 offen offset:128
    s_add_u32 s70, s70, 896
    v_and_b32 v40, v16, v253
    v_and_b32 v41, v17, v253
    v_and_b32 v42, v18, v253
    v_and_b32 v43, v19, v253
    s_nop 1
    v_mfma_f32_16x16x32_bf16 v[20:23], v[40:43], a[200:203], v[20:23]
    v_mfma_f32_16x16x32_bf16 v[24:27], v[40:43], a[204:207], v[24:27]
    s_waitcnt vmcnt(5)
    buffer_load_dwordx4 a[232:235], v3, s[52:55], s70 offen offset:0
    s_waitcnt vmcnt(5)
    buffer_load_dwordx4 a[236:239], v3, s[52:55], s70 offen offset:128
    s_add_u32 s70, s70, 896
    v_and_b32 v36, v16, v254
    v_and_b32 v37, v17, v254
    v_and_b32 v38, v18, v254
    v_and_b32 v39, v19, v254
    s_nop 1
    v_mfma_f32_16x16x32_bf16 v[20:23], v[36:39], a[208:211], v[20:23]
    v_mfma_f32_16x16x32_bf16 v[24:27], v[36:39], a[212:215], v[24:27]
    s_waitcnt vmcnt(5)
    buffer_load_dwordx4 a[240:243], v3, s[52:55], s70 offen offset:0
    s_waitcnt vmcnt(5)
    buffer_load_dwordx4 a[244:247], v3, s[52:55], s70 offen offset:128
    s_add_u32 s70, s70, 896
    v_and_b32 v40, v16, v255
    v_and_b32 v41, v17, v255
    v_and_b32 v42, v18, v255
    v_and_b32 v43, v19, v255
    s_nop 1
    v_mfma_f32_16x16x32_bf16 v[20:23], v[40:43], a[216:219], v[20:23]
    v_mfma_f32_16x16x32_bf16 v[24:27], v[40:43], a[220:223], v[24:27]
    s_branch L_vdone
L_drain3:
    s_waitcnt vmcnt(10)
    s_waitcnt vmcnt(9)
    v_and_b32 v40, v16, v255
    v_and_b32 v41, v17, v255
    v_and_b32 v42, v18, v255
    v_and_b32 v43, v19, v255
    s_nop 1
    v_mfma_f32_16x16x32_bf16 v[20:23], v[40:43], a[216:219], v[20:23]
    v_mfma_f32_16x16x32_bf16 v[24:27], v[40:43], a[220:223], v[24:27]
    s_waitcnt vmcnt(8)
    s_mov_b32 s11, s63
L_poll6:
    v_xor_b32 v9, v97, v245
    v_xor_b32 v10, v97, v247
    v_or_b32 v9, v9, v10
    v_cmp_ne_u32 vcc, 0, v9
    s_nop 1
    s_cbranch_vccz L_done6
    s_sub_u32 s11, s11, 1
    s_cbranch_scc1 L_done6
    s_sleep 8
    buffer_load_dwordx4 v[244:247], v95, s[40:43], s76 offen sc1
    s_waitcnt vmcnt(0)
    s_branch L_poll6
L_done6:
    v_lshlrev_b32 v252, 16, v244
    v_and_b32 v253, 0xffff0000, v244
    v_lshlrev_b32 v254, 16, v246
    v_and_b32 v255, 0xffff0000, v246
    v_max3_f32 v9, v252, v253, v254
    v_max_f32 v9, v9, v255
    v_cmp_gt_f32 vcc, v9, v96
    s_nop 1
    s_cbranch_vccz L_skip11
    v_mov_b32 v10, v9
    s_nop 1
    v_permlane16_swap_b32 v9, v10
    v_max_f32 v9, v9, v10
    v_mov_b32 v10, v9
    s_nop 1
    v_permlane32_swap_b32 v9, v10
    v_max_f32 v9, v9, v10
    v_max_f32 v9, v9, v96
    v_sub_f32 v10, v96, v9
    v_mul_f32 v10, s67, v10
    v_exp_f32 v10, v10
    v_mov_b32 v96, v9
    v_readlane_b32 s65, v10, 0
    v_readlane_b32 s66, v10, 8
    s_nop 1
    v_mov_b32 v10, s66
    s_mov_b32 exec_hi, 0
    v_mov_b32 v10, s65
    s_mov_b32 exec_hi, s1
    s_nop 7
    v_mul_f32 v20, v10, v20
    v_mul_f32 v21, v10, v21
    v_mul_f32 v22, v10, v22
    v_mul_f32 v23, v10, v23
    v_mul_f32 v24, v10, v24
    v_mul_f32 v25, v10, v25
    v_mul_f32 v26, v10, v26
    v_mul_f32 v27, v10, v27
L_skip11:
    v_sub_f32 v252, v252, v96
    v_sub_f32 v253, v253, v96
    v_sub_f32 v254, v254, v96
    v_sub_f32 v255, v255, v96
    v_mul_f32 v252, s67, v252
    v_mul_f32 v253, s67, v253
    v_mul_f32 v254, s67, v254
    v_mul_f32 v255, s67, v255
    v_exp_f32 v252, v252
    v_exp_f32 v253, v253
    v_exp_f32 v254, v254
    v_exp_f32 v255, v255
    v_cvt_pk_bf16_f32 v252, v252, v252
    v_cvt_pk_bf16_f32 v253, v253, v253
    v_cvt_pk_bf16_f32 v254, v254, v254
    v_cvt_pk_bf16_f32 v255, v255, v255
    v_readlane_b32 s65, v96, 0
    v_readlane_b32 s66, v96, 8
    v_mov_b32 v9, 5184
L_mlw3:
    ds_read_b32 v10, v9 offset:16
    s_waitcnt lgkmcnt(0)
    v_cmp_eq_u32 vcc, 0, v10
    s_nop 1
    s_cbranch_vccz L_mlw3_ok
    s_sleep 1
    s_branch L_mlw3
L_mlw3_ok:
    ds_read2_b32 v[12:13], v8 offset0:0 offset1:2
    v_mov_b32 v11, s66
    s_mov_b32 exec_hi, 0
    v_mov_b32 v11, s65
    s_mov_b32 exec_hi, s1
    s_waitcnt lgkmcnt(0)
    v_sub_f32 v11, v11, v12
    v_mul_f32 v11, s67, v11
    v_exp_f32 v11, v11
    s_nop 0
    v_mul_f32 v11, v11, v13
    s_waitcnt vmcnt(7)
    s_waitcnt vmcnt(6)
    v_and_b32 v36, v16, v252
    v_and_b32 v37, v17, v252
    v_and_b32 v38, v18, v252
    v_and_b32 v39, v19, v252
    s_nop 1
    v_mfma_f32_16x16x32_bf16 v[20:23], v[36:39], a[160:163], v[20:23]
    v_mfma_f32_16x16x32_bf16 v[24:27], v[36:39], a[164:167], v[24:27]
    s_waitcnt vmcnt(5)
    buffer_load_dwordx4 a[224:227], v3, s[52:55], s70 offen offset:0
    s_waitcnt vmcnt(5)
    buffer_load_dwordx4 a[228:231], v3, s[52:55], s70 offen offset:128
    s_add_u32 s70, s70, 896
    v_and_b32 v40, v16, v253
    v_and_b32 v41, v17, v253
    v_and_b32 v42, v18, v253
    v_and_b32 v43, v19, v253
    s_nop 1
    v_mfma_f32_16x16x32_bf16 v[20:23], v[40:43], a[168:171], v[20:23]
    v_mfma_f32_16x16x32_bf16 v[24:27], v[40:43], a[172:175], v[24:27]
    s_waitcnt vmcnt(5)
    buffer_load_dwordx4 a[232:235], v3, s[52:55], s70 offen offset:0
    s_waitcnt vmcnt(5)
    buffer_load_dwordx4 a[236:239], v3, s[52:55], s70 offen offset:128
    s_add_u32 s70, s70, 896
    v_and_b32 v36, v16, v254
    v_and_b32 v37, v17, v254
    v_and_b32 v38, v18, v254
    v_and_b32 v39, v19, v254
    s_nop 1
    v_mfma_f32_16x16x32_bf16 v[20:23], v[36:39], a[176:179], v[20:23]
    v_mfma_f32_16x16x32_bf16 v[24:27], v[36:39], a[180:183], v[24:27]
    s_waitcnt vmcnt(5)
    buffer_load_dwordx4 a[240:243], v3, s[52:55], s70 offen offset:0
    s_waitcnt vmcnt(5)
    buffer_load_dwordx4 a[244:247], v3, s[52:55], s70 offen offset:128
    s_add_u32 s70, s70, 896
    v_and_b32 v40, v16, v255
    v_and_b32 v41, v17, v255
    v_and_b32 v42, v18, v255
    v_and_b32 v43, v19, v255
    s_nop 1
    v_mfma_f32_16x16x32_bf16 v[20:23], v[40:43], a[184:187], v[20:23]
    v_mfma_f32_16x16x32_bf16 v[24:27], v[40:43], a[188:191], v[24:27]
    s_branch L_vdone
L_drain0:
    v_readlane_b32 s65, v96, 0
    v_readlane_b32 s66, v96, 8
    v_mov_b32 v9, 5184
L_mlw4:
    ds_read_b32 v10, v9 offset:16
    s_waitcnt lgkmcnt(0)
    v_cmp_eq_u32 vcc, 0, v10
    s_nop 1
    s_cbranch_vccz L_mlw4_ok
    s_sleep 1
    s_branch L_mlw4
L_mlw4_ok:
    ds_read2_b32 v[12:13], v8 offset0:0 offset1:2
    v_mov_b32 v11, s66
    s_mov_b32 exec_hi, 0
    v_mov_b32 v11, s65
    s_mov_b32 exec_hi, s1
    s_waitcnt lgkmcnt(0)
    v_sub_f32 v11, v11, v12
    v_mul_f32 v11, s67, v11
    v_exp_f32 v11, v11
    s_nop 0
    v_mul_f32 v11, v11, v13
    s_waitcnt vmcnt(10)
    v_and_b32 v40, v16, v81
    v_and_b32 v41, v17, v81
    v_and_b32 v42, v18, v81
    v_and_b32 v43, v19, v81
    s_nop 1
    v_mfma_f32_16x16x32_bf16 v[20:23], v[40:43], a[112:115], v[20:23]
    v_mfma_f32_16x16x32_bf16 v[24:27], v[40:43], a[116:119], v[24:27]
    s_waitcnt vmcnt(9)
    s_waitcnt vmcnt(8)
    v_and_b32 v36, v16, v82
    v_and_b32 v37, v17, v82
    v_and_b32 v38, v18, v82
    v_and_b32 v39, v19, v82
    s_nop 1
    v_mfma_f32_16x16x32_bf16 v[20:23], v[36:39], a[120:123], v[20:23]
    v_mfma_f32_16x16x32_bf16 v[24:27], v[36:39], a[124:127], v[24:27]
    s_waitcnt vmcnt(7)
    s_waitcnt vmcnt(6)
    v_and_b32 v40, v16, v83
    v_and_b32 v41, v17, v83
    v_and_b32 v42, v18, v83
    v_and_b32 v43, v19, v83
    s_nop 1
    v_mfma_f32_16x16x32_bf16 v[20:23], v[40:43], a[128:131], v[20:23]
    v_mfma_f32_16x16x32_bf16 v[24:27], v[40:43], a[132:135], v[24:27]
    s_waitcnt vmcnt(5)
    buffer_load_dwordx4 a[224:227], v3, s[52:55], s70 offen offset:0
    s_waitcnt vmcnt(5)
    buffer_load_dwordx4 a[228:231], v3, s[52:55], s70 offen offset:128
    s_add_u32 s70, s70, 896
    v_and_b32 v36, v16, v84
    v_and_b32 v37, v17, v84
    v_and_b32 v38, v18, v84
    v_and_b32 v39, v19, v84
    s_nop 1
    v_mfma_f32_16x16x32_bf16 v[20:23], v[36:39], a[136:139], v[20:23]
    v_mfma_f32_16x16x32_bf16 v[24:27], v[36:39], a[140:143], v[24:27]
    s_waitcnt vmcnt(5)
    buffer_load_dwordx4 a[232:235], v3, s[52:55], s70 offen offset:0
    s_waitcnt vmcnt(5)
    buffer_load_dwordx4 a[236:239], v3, s[52:55], s70 offen offset:128
    s_add_u32 s70, s70, 896
    v_and_b32 v40, v16, v85
    v_and_b32 v41, v17, v85
    v_and_b32 v42, v18, v85
    v_and_b32 v43, v19, v85
    s_nop 1
    v_mfma_f32_16x16x32_bf16 v[20:23], v[40:43], a[144:147], v[20:23]
    v_mfma_f32_16x16x32_bf16 v[24:27], v[40:43], a[148:151], v[24:27]
    s_waitcnt vmcnt(5)
    buffer_load_dwordx4 a[240:243], v3, s[52:55], s70 offen offset:0
    s_waitcnt vmcnt(5)
    buffer_load_dwordx4 a[244:247], v3, s[52:55], s70 offen offset:128
    s_add_u32 s70, s70, 896
    v_and_b32 v36, v16, v86
    v_and_b32 v37, v17, v86
    v_and_b32 v38, v18, v86
    v_and_b32 v39, v19, v86
    s_nop 1
    v_mfma_f32_16x16x32_bf16 v[20:23], v[36:39], a[152:155], v[20:23]
    v_mfma_f32_16x16x32_bf16 v[24:27], v[36:39], a[156:159], v[24:27]
L_vdone:
    v_mov_b32 v9, 5184
    ds_read_b32 v10, v9 offset:20
    s_nop 4
    ds_read_b128 v[28:31], v14
    ds_read_b128 v[32:35], v14 offset:1024
    ds_read_b128 v[36:39], v15
    ds_read_b128 v[40:43], v15 offset:1024
    v_mov_b32 v12, v11
    v_mov_b32 v13, v11
    v_pk_mul_f32 v[20:21], v[20:21], v[12:13]
    v_pk_mul_f32 v[22:23], v[22:23], v[12:13]
    v_pk_mul_f32 v[24:25], v[24:25], v[12:13]
    v_pk_mul_f32 v[26:27], v[26:27], v[12:13]
    s_waitcnt lgkmcnt(4)
    v_cmp_eq_u32 vcc, 2, v10
    s_nop 1
    s_cbranch_vccnz L_publish
    ds_write_b128 v4, v[20:23]
    ds_write_b128 v4, v[24:27] offset:1024
    v_mov_b32 v10, 1
    s_waitcnt lgkmcnt(0)
    s_mov_b64 exec, 1
    ds_add_rtn_u32 v10, v9, v10 offset:20
    s_mov_b64 exec, -1
    s_waitcnt lgkmcnt(0)
    v_readfirstlane_b32 s12, v10
    s_nop 1
    s_cmp_eq_u32 s12, 2
    s_cbranch_scc0 L_published
    ds_read_b128 v[28:31], v14
    ds_read_b128 v[32:35], v14 offset:1024
    ds_read_b128 v[36:39], v15
    ds_read_b128 v[40:43], v15 offset:1024
L_publish:
    s_waitcnt lgkmcnt(0)
    v_pk_add_f32 v[28:29], v[28:29], v[36:37]
    v_pk_add_f32 v[30:31], v[30:31], v[38:39]
    v_pk_add_f32 v[32:33], v[32:33], v[40:41]
    v_pk_add_f32 v[34:35], v[34:35], v[42:43]
    v_pk_add_f32 v[20:21], v[20:21], v[28:29]
    v_pk_add_f32 v[22:23], v[22:23], v[30:31]
    v_pk_add_f32 v[24:25], v[24:25], v[32:33]
    v_pk_add_f32 v[26:27], v[26:27], v[34:35]
    v_min_u32 v20, -2, v20
    v_min_u32 v21, -2, v21
    v_min_u32 v22, -2, v22
    v_min_u32 v23, -2, v23
    v_min_u32 v24, -2, v24
    v_min_u32 v25, -2, v25
    v_min_u32 v26, -2, v26
    v_min_u32 v27, -2, v27
    buffer_store_dwordx4 v[20:23], v5, s[40:43], s71 offen sc1
    buffer_store_dwordx4 v[24:27], v5, s[40:43], s73 offen sc1
    v_mov_b32 v10, 1
    ds_write_b32 v9, v10 offset:24
L_published:
    buffer_load_dwordx4 a[248:251], v3, s[52:55], s70 offen offset:0
    buffer_load_dwordx4 a[252:255], v3, s[52:55], s70 offen offset:128
    s_add_u32 s70, s70, 896
    buffer_load_dwordx4 v[240:243], v3, s[52:55], s70 offen offset:0
    buffer_load_dwordx4 v[236:239], v3, s[52:55], s70 offen offset:128
    s_add_u32 s70, s70, 896
    buffer_load_dwordx4 v[232:235], v3, s[52:55], s70 offen offset:0
    buffer_load_dwordx4 v[228:231], v3, s[52:55], s70 offen offset:128
    s_add_u32 s70, s70, 896
    buffer_load_dwordx4 v[224:227], v3, s[52:55], s70 offen offset:0
    buffer_load_dwordx4 v[220:223], v3, s[52:55], s70 offen offset:128
    s_add_u32 s70, s70, 896
    buffer_load_dwordx4 v[216:219], v3, s[52:55], s70 offen offset:0
    buffer_load_dwordx4 v[212:215], v3, s[52:55], s70 offen offset:128
    s_add_u32 s70, s70, 896
    s_barrier
    ds_read_b128 v[44:47], v6 offset:0
    ds_read_b128 v[48:51], v6 offset:16
    s_waitcnt vmcnt(0) lgkmcnt(0)
    v_and_b32 v28, v16, v44
    v_and_b32 v29, v17, v44
    v_and_b32 v30, v18, v44
    v_and_b32 v31, v19, v44
    v_and_b32 v32, v16, v45
    v_and_b32 v33, v17, v45
    v_and_b32 v34, v18, v45
    v_and_b32 v35, v19, v45
    v_mfma_f32_16x16x32_bf16 v[52:55], v[28:31], a[224:227], 0
    v_mfma_f32_16x16x32_bf16 v[56:59], v[28:31], a[228:231], 0
    v_and_b32 v36, v16, v46
    v_and_b32 v37, v17, v46
    v_and_b32 v38, v18, v46
    v_and_b32 v39, v19, v46
    v_mfma_f32_16x16x32_bf16 v[52:55], v[32:35], a[232:235], v[52:55]
    v_mfma_f32_16x16x32_bf16 v[56:59], v[32:35], a[236:239], v[56:59]
    v_and_b32 v40, v16, v47
    v_and_b32 v41, v17, v47
    v_and_b32 v42, v18, v47
    v_and_b32 v43, v19, v47
    v_mfma_f32_16x16x32_bf16 v[52:55], v[36:39], a[240:243], v[52:55]
    v_mfma_f32_16x16x32_bf16 v[56:59], v[36:39], a[244:247], v[56:59]
    v_and_b32 v28, v16, v48
    v_and_b32 v29, v17, v48
    v_and_b32 v30, v18, v48
    v_and_b32 v31, v19, v48
    v_mfma_f32_16x16x32_bf16 v[52:55], v[40:43], a[248:251], v[52:55]
    v_mfma_f32_16x16x32_bf16 v[56:59], v[40:43], a[252:255], v[56:59]
    v_and_b32 v32, v16, v49
    v_and_b32 v33, v17, v49
    v_and_b32 v34, v18, v49
    v_and_b32 v35, v19, v49
    v_mfma_f32_16x16x32_bf16 v[52:55], v[28:31], v[240:243], v[52:55]
    v_mfma_f32_16x16x32_bf16 v[56:59], v[28:31], v[236:239], v[56:59]
    v_and_b32 v36, v16, v50
    v_and_b32 v37, v17, v50
    v_and_b32 v38, v18, v50
    v_and_b32 v39, v19, v50
    v_mfma_f32_16x16x32_bf16 v[52:55], v[32:35], v[232:235], v[52:55]
    v_mfma_f32_16x16x32_bf16 v[56:59], v[32:35], v[228:231], v[56:59]
    v_and_b32 v40, v16, v51
    v_and_b32 v41, v17, v51
    v_and_b32 v42, v18, v51
    v_and_b32 v43, v19, v51
    v_mfma_f32_16x16x32_bf16 v[52:55], v[36:39], v[224:227], v[52:55]
    v_mfma_f32_16x16x32_bf16 v[56:59], v[36:39], v[220:223], v[56:59]
    v_mfma_f32_16x16x32_bf16 v[52:55], v[40:43], v[216:219], v[52:55]
    v_mfma_f32_16x16x32_bf16 v[56:59], v[40:43], v[212:215], v[56:59]
    s_nop 6
    v_permlane32_swap_b32 v52, v64
    v_permlane32_swap_b32 v53, v65
    v_permlane32_swap_b32 v54, v66
    v_permlane32_swap_b32 v55, v67
    v_permlane32_swap_b32 v56, v68
    v_permlane32_swap_b32 v57, v69
    v_permlane32_swap_b32 v58, v70
    v_permlane32_swap_b32 v59, v71
    v_add_f32_dpp v52, v64, v52 row_ror:8 row_mask:0xf bank_mask:0x3
    v_add_f32_dpp v53, v65, v53 row_ror:8 row_mask:0xf bank_mask:0x3
    v_add_f32_dpp v54, v66, v54 row_ror:8 row_mask:0xf bank_mask:0x3
    v_add_f32_dpp v55, v67, v55 row_ror:8 row_mask:0xf bank_mask:0x3
    v_mov_b32_dpp v52, v56 row_ror:8 row_mask:0xf bank_mask:0xc
    v_mov_b32_dpp v53, v57 row_ror:8 row_mask:0xf bank_mask:0xc
    v_mov_b32_dpp v54, v58 row_ror:8 row_mask:0xf bank_mask:0xc
    v_mov_b32_dpp v55, v59 row_ror:8 row_mask:0xf bank_mask:0xc
    v_add_f32_dpp v52, v68, v52 quad_perm:[0,1,2,3] row_mask:0xf bank_mask:0xc
    v_add_f32_dpp v53, v69, v53 quad_perm:[0,1,2,3] row_mask:0xf bank_mask:0xc
    v_add_f32_dpp v54, v70, v54 quad_perm:[0,1,2,3] row_mask:0xf bank_mask:0xc
    v_add_f32_dpp v55, v71, v55 quad_perm:[0,1,2,3] row_mask:0xf bank_mask:0xc
    v_min_u32 v52, -2, v52
    v_min_u32 v53, -2, v53
    v_min_u32 v54, -2, v54
    v_min_u32 v55, -2, v55
    s_mov_b32 exec_hi, 0
    buffer_store_dwordx4 v[52:55], v7, s[40:43], s72 offen sc1
    s_endpgm
L_helper:
    s_load_dword s10, s[38:39], 0
    v_lshlrev_b32 v1, 4, v0
    v_mov_b32 v41, 5120
    v_mov_b32 v42, 0
    v_mov_b32 v43, 0
    ds_write_b32 v41, v42 offset:4
    ds_write_b64 v41, v[42:43] offset:8
    ds_write_b64 v41, v[42:43] offset:80
    ds_write_b32 v41, v42 offset:88
    s_lshr_b32 s6, s8, 3
    s_and_b32 s4, s8, 7
    s_lshl_b32 s9, s4, 3
    s_add_u32 s9, s9, s7
    s_mov_b32 s5, 0
    s_mov_b64 s[0:1], -1
    s_mov_b32 s40, s38
    s_mov_b32 s41, s39
    s_mov_b32 s42, 4194304
    s_mov_b32 s43, 0x20000
    s_cmp_lt_u32 s15, 120
    s_cbranch_scc0 L_noln
    v_lshlrev_b32 v15, 10, v4
    v_add_u32 v15, v15, v6
    s_mov_b32 s13, 3
    s_mov_b32 s74, 0xffff0000
    s_mov_b32 s75, 0
    s_mov_b32 s76, 0
    s_mov_b32 s77, 0xffff
    s_mov_b32 s78, 0
    s_mov_b32 s79, 0xffff0000
    v_and_b32 v8, 3, v0
    v_lshlrev_b32 v9, 10, v8
    v_lshlrev_b32 v10, 4, v4
    v_add_u32 v9, v9, v10
    v_bfe_u32 v10, v0, 2, 2
    v_lshlrev_b32 v11, 3, v4
    v_add_u32 v10, v10, v11
    v_lshlrev_b32 v10, 7, v10
    v_lshlrev_b32 v11, 3, v8
    v_add_u32 v10, v10, v11
    s_lshl_b32 s12, s13, 5
    v_add_u32 v10, s12, v10
    v_mov_b32 v12, 5120
    v_mul_u32_u24 v11, 30720, v4
    v_lshlrev_b32 v13, 2, v5
    v_add_u32 v11, v11, v13
    s_lshl_b32 s72, s15, 6
    s_lshl_b32 s12, s13, 4
    s_add_u32 s72, s72, s12
    s_lshl_b32 s72, s72, 2
    s_add_u32 s72, s72, 4096
    s_waitcnt vmcnt(4) lgkmcnt(0)
    v_lshlrev_b32 v64, 16, v16
    v_and_b32 v65, 0xffff0000, v16
    v_lshlrev_b32 v66, 16, v17
    v_and_b32 v67, 0xffff0000, v17
    v_lshlrev_b32 v68, 16, v18
    v_and_b32 v69, 0xffff0000, v18
    v_lshlrev_b32 v70, 16, v19
    v_and_b32 v71, 0xffff0000, v19
    v_lshlrev_b32 v72, 16, v20
    v_and_b32 v73, 0xffff0000, v20
    v_lshlrev_b32 v74, 16, v21
    v_and_b32 v75, 0xffff0000, v21
    v_lshlrev_b32 v76, 16, v22
    v_and_b32 v77, 0xffff0000, v22
    v_lshlrev_b32 v78, 16, v23
    v_and_b32 v79, 0xffff0000, v23
    v_lshlrev_b32 v80, 16, v24
    v_and_b32 v81, 0xffff0000, v24
    v_lshlrev_b32 v82, 16, v25
    v_and_b32 v83, 0xffff0000, v25
    v_lshlrev_b32 v84, 16, v26
    v_and_b32 v85, 0xffff0000, v26
    v_lshlrev_b32 v86, 16, v27
    v_and_b32 v87, 0xffff0000, v27
    v_lshlrev_b32 v88, 16, v28
    v_and_b32 v89, 0xffff0000, v28
    v_lshlrev_b32 v90, 16, v29
    v_and_b32 v91, 0xffff0000, v29
    v_lshlrev_b32 v92, 16, v30
    v_and_b32 v93, 0xffff0000, v30
    v_lshlrev_b32 v94, 16, v31
    v_and_b32 v95, 0xffff0000, v31
    v_pk_add_f32 v[32:33], v[64:65], v[66:67]
    v_pk_add_f32 v[34:35], v[68:69], v[70:71]
    v_pk_add_f32 v[32:33], v[32:33], v[72:73]
    v_pk_add_f32 v[34:35], v[34:35], v[74:75]
    v_pk_add_f32 v[32:33], v[32:33], v[76:77]
    v_pk_add_f32 v[34:35], v[34:35], v[78:79]
    v_pk_add_f32 v[32:33], v[32:33], v[80:81]
    v_pk_add_f32 v[34:35], v[34:35], v[82:83]
    v_pk_add_f32 v[32:33], v[32:33], v[84:85]
    v_pk_add_f32 v[34:35], v[34:35], v[86:87]
    v_pk_add_f32 v[32:33], v[32:33], v[88:89]
    v_pk_add_f32 v[34:35], v[34:35], v[90:91]
    v_pk_add_f32 v[32:33], v[32:33], v[92:93]
    v_pk_add_f32 v[34:35], v[34:35], v[94:95]
    v_pk_add_f32 v[32:33], v[32:33], v[34:35]
    v_add_f32 v32, v32, v33
    s_nop 1
    v_add_f32_dpp v32, v32, v32 row_ror:8 row_mask:0xf bank_mask:0xf
    s_nop 1
    v_add_f32_dpp v32, v32, v32 row_ror:4 row_mask:0xf bank_mask:0xf
    s_nop 1
    v_add_f32_dpp v32, v32, v32 row_ror:2 row_mask:0xf bank_mask:0xf
    s_nop 1
    v_add_f32_dpp v32, v32, v32 row_ror:1 row_mask:0xf bank_mask:0xf
    s_mov_b32 s12, 991054117
    v_mul_f32 v32, s12, v32
    v_mov_b32 v33, v32
    v_mov_b32 v34, 0
    v_mov_b32 v35, 0
    v_mov_b32 v36, 0
    v_mov_b32 v37, 0
    v_pk_add_f32 v[38:39], v[64:65], v[32:33] neg_lo:[0,1] neg_hi:[0,1]
    v_pk_add_f32 v[40:41], v[66:67], v[32:33] neg_lo:[0,1] neg_hi:[0,1]
    v_pk_fma_f32 v[34:35], v[38:39], v[38:39], v[34:35]
    v_pk_fma_f32 v[36:37], v[40:41], v[40:41], v[36:37]
    v_pk_add_f32 v[38:39], v[68:69], v[32:33] neg_lo:[0,1] neg_hi:[0,1]
    v_pk_add_f32 v[40:41], v[70:71], v[32:33] neg_lo:[0,1] neg_hi:[0,1]
    v_pk_fma_f32 v[34:35], v[38:39], v[38:39], v[34:35]
    v_pk_fma_f32 v[36:37], v[40:41], v[40:41], v[36:37]
    v_pk_add_f32 v[38:39], v[72:73], v[32:33] neg_lo:[0,1] neg_hi:[0,1]
    v_pk_add_f32 v[40:41], v[74:75], v[32:33] neg_lo:[0,1] neg_hi:[0,1]
    v_pk_fma_f32 v[34:35], v[38:39], v[38:39], v[34:35]
    v_pk_fma_f32 v[36:37], v[40:41], v[40:41], v[36:37]
    v_pk_add_f32 v[38:39], v[76:77], v[32:33] neg_lo:[0,1] neg_hi:[0,1]
    v_pk_add_f32 v[40:41], v[78:79], v[32:33] neg_lo:[0,1] neg_hi:[0,1]
    v_pk_fma_f32 v[34:35], v[38:39], v[38:39], v[34:35]
    v_pk_fma_f32 v[36:37], v[40:41], v[40:41], v[36:37]
    v_pk_add_f32 v[38:39], v[80:81], v[32:33] neg_lo:[0,1] neg_hi:[0,1]
    v_pk_add_f32 v[40:41], v[82:83], v[32:33] neg_lo:[0,1] neg_hi:[0,1]
    v_pk_fma_f32 v[34:35], v[38:39], v[38:39], v[34:35]
    v_pk_fma_f32 v[36:37], v[40:41], v[40:41], v[36:37]
    v_pk_add_f32 v[38:39], v[84:85], v[32:33] neg_lo:[0,1] neg_hi:[0,1]
    v_pk_add_f32 v[40:41], v[86:87], v[32:33] neg_lo:[0,1] neg_hi:[0,1]
    v_pk_fma_f32 v[34:35], v[38:39], v[38:39], v[34:35]
    v_pk_fma_f32 v[36:37], v[40:41], v[40:41], v[36:37]
    v_pk_add_f32 v[38:39], v[88:89], v[32:33] neg_lo:[0,1] neg_hi:[0,1]
    v_pk_add_f32 v[40:41], v[90:91], v[32:33] neg_lo:[0,1] neg_hi:[0,1]
    v_pk_fma_f32 v[34:35], v[38:39], v[38:39], v[34:35]
    v_pk_fma_f32 v[36:37], v[40:41], v[40:41], v[36:37]
    v_pk_add_f32 v[38:39], v[92:93], v[32:33] neg_lo:[0,1] neg_hi:[0,1]
    v_pk_add_f32 v[40:41], v[94:95], v[32:33] neg_lo:[0,1] neg_hi:[0,1]
    v_pk_fma_f32 v[34:35], v[38:39], v[38:39], v[34:35]
    v_pk_fma_f32 v[36:37], v[40:41], v[40:41], v[36:37]
    v_pk_add_f32 v[34:35], v[34:35], v[36:37]
    v_add_f32 v34, v34, v35
    v_cndmask_b32 v34, v34, 0, s[80:81]
    s_nop 1
    v_add_f32_dpp v34, v34, v34 row_ror:8 row_mask:0xf bank_mask:0xf
    s_nop 1
    v_add_f32_dpp v34, v34, v34 row_ror:4 row_mask:0xf bank_mask:0xf
    s_nop 1
    v_add_f32_dpp v34, v34, v34 row_ror:2 row_mask:0xf bank_mask:0xf
    s_nop 1
    v_add_f32_dpp v34, v34, v34 row_ror:1 row_mask:0xf bank_mask:0xf
    v_mul_f32 v34, s12, v34
    v_cvt_pk_bf16_f32 v32, v32, v32
    v_and_b32 v32, 0xffff0000, v32
    v_mov_b32 v33, v32
    v_cvt_pk_bf16_f32 v34, v34, v34
    v_and_b32 v34, 0xffff0000, v34
    v_add_f32 v34, 0x3727c5ac, v34
    v_cvt_pk_bf16_f32 v34, v34, v34
    v_and_b32 v34, 0xffff0000, v34
    v_sqrt_f32 v34, v34
    s_nop 0
    v_cvt_pk_bf16_f32 v34, v34, v34
    v_and_b32 v34, 0xffff0000, v34
    v_rcp_f32 v34, v34
    s_nop 0
    v_mov_b32 v35, v34
    v_pk_add_f32 v[64:65], v[64:65], v[32:33] neg_lo:[0,1] neg_hi:[0,1]
    v_pk_add_f32 v[66:67], v[66:67], v[32:33] neg_lo:[0,1] neg_hi:[0,1]
    v_pk_add_f32 v[68:69], v[68:69], v[32:33] neg_lo:[0,1] neg_hi:[0,1]
    v_pk_add_f32 v[70:71], v[70:71], v[32:33] neg_lo:[0,1] neg_hi:[0,1]
    v_pk_add_f32 v[72:73], v[72:73], v[32:33] neg_lo:[0,1] neg_hi:[0,1]
    v_pk_add_f32 v[74:75], v[74:75], v[32:33] neg_lo:[0,1] neg_hi:[0,1]
    v_pk_add_f32 v[76:77], v[76:77], v[32:33] neg_lo:[0,1] neg_hi:[0,1]
    v_pk_add_f32 v[78:79], v[78:79], v[32:33] neg_lo:[0,1] neg_hi:[0,1]
    v_pk_add_f32 v[80:81], v[80:81], v[32:33] neg_lo:[0,1] neg_hi:[0,1]
    v_pk_add_f32 v[82:83], v[82:83], v[32:33] neg_lo:[0,1] neg_hi:[0,1]
    v_pk_add_f32 v[84:85], v[84:85], v[32:33] neg_lo:[0,1] neg_hi:[0,1]
    v_pk_add_f32 v[86:87], v[86:87], v[32:33] neg_lo:[0,1] neg_hi:[0,1]
    v_pk_add_f32 v[88:89], v[88:89], v[32:33] neg_lo:[0,1] neg_hi:[0,1]
    v_pk_add_f32 v[90:91], v[90:91], v[32:33] neg_lo:[0,1] neg_hi:[0,1]
    v_pk_add_f32 v[92:93], v[92:93], v[32:33] neg_lo:[0,1] neg_hi:[0,1]
    v_pk_add_f32 v[94:95], v[94:95], v[32:33] neg_lo:[0,1] neg_hi:[0,1]
    v_cvt_pk_bf16_f32 v16, v64, v65
    v_cvt_pk_bf16_f32 v17, v66, v67
    v_cvt_pk_bf16_f32 v18, v68, v69
    v_cvt_pk_bf16_f32 v19, v70, v71
    v_cvt_pk_bf16_f32 v20, v72, v73
    v_cvt_pk_bf16_f32 v21, v74, v75
    v_cvt_pk_bf16_f32 v22, v76, v77
    v_cvt_pk_bf16_f32 v23, v78, v79
    v_cvt_pk_bf16_f32 v24, v80, v81
    v_cvt_pk_bf16_f32 v25, v82, v83
    v_cvt_pk_bf16_f32 v26, v84, v85
    v_cvt_pk_bf16_f32 v27, v86, v87
    v_cvt_pk_bf16_f32 v28, v88, v89
    v_cvt_pk_bf16_f32 v29, v90, v91
    v_cvt_pk_bf16_f32 v30, v92, v93
    v_cvt_pk_bf16_f32 v31, v94, v95
    v_lshlrev_b32 v64, 16, v16
    v_and_b32 v65, 0xffff0000, v16
    v_lshlrev_b32 v66, 16, v17
    v_and_b32 v67, 0xffff0000, v17
    v_lshlrev_b32 v68, 16, v18
    v_and_b32 v69, 0xffff0000, v18
    v_lshlrev_b32 v70, 16, v19
    v_and_b32 v71, 0xffff0000, v19
    v_lshlrev_b32 v72, 16, v20
    v_and_b32 v73, 0xffff0000, v20
    v_lshlrev_b32 v74, 16, v21
    v_and_b32 v75, 0xffff0000, v21
    v_lshlrev_b32 v76, 16, v22
    v_and_b32 v77, 0xffff0000, v22
    v_lshlrev_b32 v78, 16, v23
    v_and_b32 v79, 0xffff0000, v23
    v_lshlrev_b32 v80, 16, v24
    v_and_b32 v81, 0xffff0000, v24
    v_lshlrev_b32 v82, 16, v25
    v_and_b32 v83, 0xffff0000, v25
    v_lshlrev_b32 v84, 16, v26
    v_and_b32 v85, 0xffff0000, v26
    v_lshlrev_b32 v86, 16, v27
    v_and_b32 v87, 0xffff0000, v27
    v_lshlrev_b32 v88, 16, v28
    v_and_b32 v89, 0xffff0000, v28
    v_lshlrev_b32 v90, 16, v29
    v_and_b32 v91, 0xffff0000, v29
    v_lshlrev_b32 v92, 16, v30
    v_and_b32 v93, 0xffff0000, v30
    v_lshlrev_b32 v94, 16, v31
    v_and_b32 v95, 0xffff0000, v31
    v_pk_mul_f32 v[64:65], v[64:65], v[34:35]
    v_pk_mul_f32 v[66:67], v[66:67], v[34:35]
    v_pk_mul_f32 v[68:69], v[68:69], v[34:35]
    v_pk_mul_f32 v[70:71], v[70:71], v[34:35]
    v_pk_mul_f32 v[72:73], v[72:73], v[34:35]
    v_pk_mul_f32 v[74:75], v[74:75], v[34:35]
    v_pk_mul_f32 v[76:77], v[76:77], v[34:35]
    v_pk_mul_f32 v[78:79], v[78:79], v[34:35]
    v_pk_mul_f32 v[80:81], v[80:81], v[34:35]
    v_pk_mul_f32 v[82:83], v[82:83], v[34:35]
    v_pk_mul_f32 v[84:85], v[84:85], v[34:35]
    v_pk_mul_f32 v[86:87], v[86:87], v[34:35]
    v_pk_mul_f32 v[88:89], v[88:89], v[34:35]
    v_pk_mul_f32 v[90:91], v[90:91], v[34:35]
    v_pk_mul_f32 v[92:93], v[92:93], v[34:35]
    v_pk_mul_f32 v[94:95], v[94:95], v[34:35]
    v_cvt_pk_bf16_f32 v16, v64, v65
    v_cvt_pk_bf16_f32 v17, v66, v67
    v_cvt_pk_bf16_f32 v18, v68, v69
    v_cvt_pk_bf16_f32 v19, v70, v71
    v_cvt_pk_bf16_f32 v20, v72, v73
    v_cvt_pk_bf16_f32 v21, v74, v75
    v_cvt_pk_bf16_f32 v22, v76, v77
    v_cvt_pk_bf16_f32 v23, v78, v79
    v_cvt_pk_bf16_f32 v24, v80, v81
    v_cvt_pk_bf16_f32 v25, v82, v83
    v_cvt_pk_bf16_f32 v26, v84, v85
    v_cvt_pk_bf16_f32 v27, v86, v87
    v_cvt_pk_bf16_f32 v28, v88, v89
    v_cvt_pk_bf16_f32 v29, v90, v91
    v_cvt_pk_bf16_f32 v30, v92, v93
    v_cvt_pk_bf16_f32 v31, v94, v95
    ds_write_b128 v15, v[16:19] offset:0
    ds_write_b128 v15, v[20:23] offset:16
    ds_write_b128 v15, v[24:27] offset:32
    ds_write_b128 v15, v[28:31] offset:48
    s_add_u32 s12, s10, 1
    v_mov_b32 v42, s12
    ds_write_b32 v12, v42
    s_waitcnt lgkmcnt(0)
    s_barrier
    ds_read_b128 v[100:103], v9 offset:0
    ds_read_b128 v[104:107], v9 offset:64
    ds_read_b128 v[108:111], v9 offset:128
    ds_read_b128 v[112:115], v9 offset:192
    ds_read_b128 v[116:119], v9 offset:256
    ds_read_b128 v[120:123], v9 offset:320
    ds_read_b128 v[124:127], v9 offset:384
    ds_read_b128 v[128:131], v9 offset:448
    ds_read_b128 v[132:135], v9 offset:512
    ds_read_b128 v[136:139], v9 offset:576
    ds_read_b128 v[140:143], v9 offset:640
    ds_read_b128 v[144:147], v9 offset:704
    ds_read_b128 v[148:151], v9 offset:768
    ds_read_b128 v[152:155], v9 offset:832
    ds_read_b32 v13, v12
    s_waitcnt lgkmcnt(1)
    ds_read_b64_tr_b16 v[156:157], v10 offset:8192
    ds_read_b64_tr_b16 v[158:159], v10 offset:8704
    ds_read_b64_tr_b16 v[160:161], v10 offset:12288
    ds_read_b64_tr_b16 v[162:163], v10 offset:12800
    ds_read_b64_tr_b16 v[164:165], v10 offset:16384
    ds_read_b64_tr_b16 v[166:167], v10 offset:16896
    ds_read_b64_tr_b16 v[168:169], v10 offset:20480
    ds_read_b64_tr_b16 v[170:171], v10 offset:20992
    ds_read_b64_tr_b16 v[172:173], v10 offset:24576
    ds_read_b64_tr_b16 v[174:175], v10 offset:25088
    ds_read_b64_tr_b16 v[176:177], v10 offset:28672
    ds_read_b64_tr_b16 v[178:179], v10 offset:29184
    ds_read_b64_tr_b16 v[180:181], v10 offset:32768
    ds_read_b64_tr_b16 v[182:183], v10 offset:33280
    s_waitcnt lgkmcnt(1)
    ds_read_b64_tr_b16 v[184:185], v10 offset:36864
    ds_read_b64_tr_b16 v[186:187], v10 offset:37376
    ds_read_b64_tr_b16 v[188:189], v10 offset:40960
    ds_read_b64_tr_b16 v[190:191], v10 offset:41472
    ds_read_b64_tr_b16 v[192:193], v10 offset:45056
    ds_read_b64_tr_b16 v[194:195], v10 offset:45568
    ds_read_b64_tr_b16 v[196:197], v10 offset:49152
    ds_read_b64_tr_b16 v[198:199], v10 offset:49664
    ds_read_b64_tr_b16 v[200:201], v10 offset:53248
    ds_read_b64_tr_b16 v[202:203], v10 offset:53760
    ds_read_b64_tr_b16 v[204:205], v10 offset:57344
    ds_read_b64_tr_b16 v[206:207], v10 offset:57856
    ds_read_b64_tr_b16 v[208:209], v10 offset:61440
    ds_read_b64_tr_b16 v[210:211], v10 offset:61952
    s_waitcnt lgkmcnt(14)
    v_mfma_f32_16x16x32_bf16 v[28:31], v[100:103], v[156:159], 0
    v_mfma_f32_16x16x32_bf16 v[32:35], v[104:107], v[160:163], 0
    v_mfma_f32_16x16x32_bf16 v[28:31], v[108:111], v[164:167], v[28:31]
    v_mfma_f32_16x16x32_bf16 v[32:35], v[112:115], v[168:171], v[32:35]
    v_mfma_f32_16x16x32_bf16 v[28:31], v[116:119], v[172:175], v[28:31]
    v_mfma_f32_16x16x32_bf16 v[32:35], v[120:123], v[176:179], v[32:35]
    v_mfma_f32_16x16x32_bf16 v[28:31], v[124:127], v[180:183], v[28:31]
    s_waitcnt lgkmcnt(0)
    v_mfma_f32_16x16x32_bf16 v[32:35], v[128:131], v[184:187], v[32:35]
    v_mfma_f32_16x16x32_bf16 v[28:31], v[132:135], v[188:191], v[28:31]
    v_mfma_f32_16x16x32_bf16 v[32:35], v[136:139], v[192:195], v[32:35]
    v_mfma_f32_16x16x32_bf16 v[28:31], v[140:143], v[196:199], v[28:31]
    v_mfma_f32_16x16x32_bf16 v[32:35], v[144:147], v[200:203], v[32:35]
    v_mfma_f32_16x16x32_bf16 v[28:31], v[148:151], v[204:207], v[28:31]
    v_mfma_f32_16x16x32_bf16 v[32:35], v[152:155], v[208:211], v[32:35]
    s_nop 7
    v_add_f32 v28, v28, v32
    v_add_f32 v29, v29, v33
    v_add_f32 v30, v30, v34
    v_add_f32 v31, v31, v35
    v_cndmask_b32 v32, v28, v29, s[74:75]
    v_cndmask_b32 v32, v32, v30, s[76:77]
    v_cndmask_b32 v32, v32, v31, s[78:79]
    s_nop 1
    v_mov_b32_dpp v33, v32 quad_perm:[1,0,3,2] row_mask:0xf bank_mask:0xf
    v_cvt_pk_bf16_f32 v12, v32, v33
    s_mov_b32 exec_lo, 0x55555555
    s_mov_b32 exec_hi, 0x55555555
    buffer_store_dwordx2 v[12:13], v11, s[40:43], s72 offen sc1
    s_mov_b64 exec, -1
L_noln:
    s_sub_u32 s14, s15, 120
    s_waitcnt lgkmcnt(0)
    s_add_u32 s10, s10, 1
    s_lshl_b32 s72, s2, 11
    s_add_u32 s72, s72, 1572864
    s_lshl_b32 s80, s8, 8
    s_add_u32 s80, s80, 786432
    v_mov_b32 v45, 0
    s_cmp_lg_u32 s7, 0
    s_cbranch_scc1 L_nocnt
    v_mov_b32 v46, 1048576
    v_mov_b32 v47, s10
    s_mov_b64 exec, 1
    buffer_store_dword v46, v45, s[40:43], s80 offen sc1
    s_waitcnt vmcnt(0)
    buffer_store_dword v47, v45, s[40:43], s80 offen offset:128 sc1
    s_mov_b64 exec, -1
L_nocnt:
    s_cmp_lg_u32 s2, 5
    s_cbranch_scc1 L_noprb
    s_add_u32 s76, s38, 983040
    s_addc_u32 s77, s39, 0
    s_mov_b32 s78, -1
    s_mov_b32 s79, -1
    s_mov_b32 s12, 0
    s_memtime s[74:75]
    s_waitcnt lgkmcnt(0)
    s_atomic_add s12, s[76:77], 0 glc
    s_waitcnt lgkmcnt(0)
    s_memtime s[68:69]
    s_waitcnt lgkmcnt(0)
    s_sub_u32 s12, s68, s74
    s_min_u32 s78, s78, s12
    s_mov_b32 s12, 0
    s_memtime s[74:75]
    s_waitcnt lgkmcnt(0)
    s_atomic_add s12, s[76:77], 8192 glc
    s_waitcnt lgkmcnt(0)
    s_memtime s[68:69]
    s_waitcnt lgkmcnt(0)
    s_sub_u32 s12, s68, s74
    s_min_u32 s79, s79, s12
    s_mov_b32 s12, 0
    s_memtime s[74:75]
    s_waitcnt lgkmcnt(0)
    s_atomic_add s12, s[76:77], 0 glc
    s_waitcnt lgkmcnt(0)
    s_memtime s[68:69]
    s_waitcnt lgkmcnt(0)
    s_sub_u32 s12, s68, s74
    s_min_u32 s78, s78, s12
    s_mov_b32 s12, 0
    s_memtime s[74:75]
    s_waitcnt lgkmcnt(0)
    s_atomic_add s12, s[76:77], 8192 glc
    s_waitcnt lgkmcnt(0)
    s_memtime s[68:69]
    s_waitcnt lgkmcnt(0)
    s_sub_u32 s12, s68, s74
    s_min_u32 s79, s79, s12
    s_mov_b32 s12, 0
    s_memtime s[74:75]
    s_waitcnt lgkmcnt(0)
    s_atomic_add s12, s[76:77], 0 glc
    s_waitcnt lgkmcnt(0)
    s_memtime s[68:69]
    s_waitcnt lgkmcnt(0)
    s_sub_u32 s12, s68, s74
    s_min_u32 s78, s78, s12
    s_mov_b32 s12, 0
    s_memtime s[74:75]
    s_waitcnt lgkmcnt(0)
    s_atomic_add s12, s[76:77], 8192 glc
    s_waitcnt lgkmcnt(0)
    s_memtime s[68:69]
    s_waitcnt lgkmcnt(0)
    s_sub_u32 s12, s68, s74
    s_min_u32 s79, s79, s12
    s_getreg_b32 s12, hwreg(HW_REG_XCC_ID)
    s_bfe_u32 s12, s12, 0x10002
    s_cmp_lt_u32 s79, s78
    s_addc_u32 s12, s12, 0
    s_and_b32 s12, s12, 1
    s_lshl_b32 s12, s12, 13
    v_mov_b32 v46, s10
    v_mov_b32 v47, s12
    s_mov_b32 s12, 1015808
    s_mov_b64 exec, 1
    buffer_store_dwordx2 v[46:47], v45, s[40:43], s12 offen sc1
    s_mov_b64 exec, -1
L_noprb:
    s_cmp_lt_u32 s15, 120
    s_cbranch_scc1 L_nob0h
    s_barrier
L_nob0h:
    v_mov_b32 v41, 5120
L_hq:
    ds_read_b32 v40, v41 offset:8
    s_waitcnt lgkmcnt(0)
    v_cmp_eq_u32 vcc, 0, v40
    s_nop 1
    s_cbranch_vccz L_hq_ok
    s_sleep 4
    s_branch L_hq
L_hq_ok:
    s_mov_b32 s81, 1015808
    s_mul_i32 s12, s6, 30720
    s_lshl_b32 s13, s4, 11
    s_add_u32 s12, s12, s13
    s_add_u32 s12, s12, 4096
    s_mov_b32 s11, 200000
L_poll7:
    buffer_load_dwordx4 v[32:35], v1, s[40:43], s12 offen sc1
    buffer_load_dwordx4 v[36:39], v1, s[40:43], s12 offen offset:1024 sc1
    buffer_load_dword v46, v45, s[40:43], s80 offen offset:128 sc1
    buffer_load_dwordx2 v[48:49], v45, s[40:43], s81 offen sc1
    s_waitcnt vmcnt(0)
    v_xor_b32 v40, s10, v33
    v_xor_b32 v41, s10, v35
    v_xor_b32 v42, s10, v37
    v_xor_b32 v43, s10, v39
    v_xor_b32 v46, s10, v46
    v_xor_b32 v47, s10, v48
    v_or3_b32 v40, v40, v41, v42
    v_or3_b32 v40, v40, v43, v46
    v_or_b32 v40, v40, v47
    v_cmp_ne_u32 vcc, 0, v40
    s_nop 1
    s_cbranch_vccz L_done7
    s_mov_b64 exec, vcc
    s_sub_u32 s11, s11, 1
    s_cbranch_scc1 L_done7
    s_sleep 16
    s_branch L_poll7
L_done7:
    s_mov_b64 exec, s[0:1]
    v_lshlrev_b32 v40, 3, v0
    v_add_u32 v40, 4096, v40
    ds_write2_b32 v40, v32, v34 offset0:0 offset1:1
    ds_write2_b32 v40, v36, v38 offset0:128 offset1:129
    v_and_b32 v49, 8192, v49
    v_mov_b32 v41, 5120
    v_mov_b32 v42, s10
    ds_write_b32 v41, v42
    ds_write_b32 v41, v49 offset:16
    v_readfirstlane_b32 s81, v49
    s_waitcnt lgkmcnt(0)
    s_nop 0
    s_xor_b32 s72, s72, s81
    v_mov_b32 v44, 1
    ds_write_b32 v41, v44 offset:4
    s_lshl_b32 s12, s6, 6
    s_add_u32 s12, s12, s9
    s_lshl_b32 s12, s12, 2
    s_add_u32 s12, s12, 720896
    v_mov_b32 v43, 0
    s_mov_b64 exec, 1
    buffer_store_dword v42, v43, s[40:43], s12 offen sc1
    s_mov_b64 exec, -1
    s_cmp_ge_u32 s14, 28
    s_cbranch_scc1 L_nod1
    s_mov_b32 s74, 0xffff0000
    s_mov_b32 s75, 0
    s_mov_b32 s76, 0
    s_mov_b32 s77, 0xffff
    s_mov_b32 s78, 0
    s_mov_b32 s79, 0xffff0000
    v_mul_u32_u24 v40, 30720, v4
    v_lshlrev_b32 v41, 4, v5
    v_add_u32 v40, v40, v41
    s_lshl_b32 s12, s14, 8
    s_add_u32 s12, s12, 20480
    s_add_u32 s13, s12, 7168
    s_mov_b32 s11, 200000
L_poll8:
    buffer_load_dwordx4 v[16:19], v40, s[40:43], s12 offen sc1
    buffer_load_dwordx4 v[20:23], v40, s[40:43], s13 offen sc1
    s_waitcnt vmcnt(0)
    v_xor_b32 v24, s10, v17
    v_xor_b32 v25, s10, v19
    v_xor_b32 v26, s10, v21
    v_xor_b32 v27, s10, v23
    v_or3_b32 v24, v24, v25, v26
    v_or_b32 v24, v24, v27
    v_cmp_ne_u32 vcc, 0, v24
    s_nop 1
    s_cbranch_vccz L_done8
    s_mov_b64 exec, vcc
    s_sub_u32 s11, s11, 1
    s_cbranch_scc1 L_done8
    s_sleep 32
    s_branch L_poll8
L_done8:
    s_mov_b64 exec, s[0:1]
    s_mov_b32 s13, 3216550459
    v_lshlrev_b32 v24, 16, v16
    v_and_b32 v25, 0xffff0000, v16
    v_lshlrev_b32 v28, 16, v20
    v_and_b32 v29, 0xffff0000, v20
    v_lshlrev_b32 v26, 16, v18
    v_and_b32 v27, 0xffff0000, v18
    v_lshlrev_b32 v30, 16, v22
    v_and_b32 v31, 0xffff0000, v22
    v_mul_f32 v32, s13, v24
    v_mul_f32 v33, s13, v25
    v_mul_f32 v34, s13, v26
    v_mul_f32 v35, s13, v27
    v_exp_f32 v32, v32
    v_exp_f32 v33, v33
    v_exp_f32 v34, v34
    v_exp_f32 v35, v35
    v_add_f32 v32, 1.0, v32
    v_add_f32 v33, 1.0, v33
    v_add_f32 v34, 1.0, v34
    v_add_f32 v35, 1.0, v35
    v_rcp_f32 v32, v32
    v_rcp_f32 v33, v33
    v_rcp_f32 v34, v34
    v_rcp_f32 v35, v35
    v_mul_f32 v32, v24, v32
    v_mul_f32 v33, v25, v33
    v_mul_f32 v34, v26, v34
    v_mul_f32 v35, v27, v35
    v_cvt_pk_bf16_f32 v32, v32, v32
    v_and_b32 v32, 0xffff0000, v32
    v_cvt_pk_bf16_f32 v33, v33, v33
    v_and_b32 v33, 0xffff0000, v33
    v_cvt_pk_bf16_f32 v34, v34, v34
    v_and_b32 v34, 0xffff0000, v34
    v_cvt_pk_bf16_f32 v35, v35, v35
    v_and_b32 v35, 0xffff0000, v35
    v_mul_f32 v32, v32, v28
    v_mul_f32 v33, v33, v29
    v_mul_f32 v34, v34, v30
    v_mul_f32 v35, v35, v31
    v_cvt_pk_bf16_f32 v32, v32, v33
    v_cvt_pk_bf16_f32 v33, v34, v35
    v_lshlrev_b32 v34, 3, v0
    ds_write_b64 v34, v[32:33] offset:5696
    v_and_b32 v48, 3, v0
    v_lshlrev_b32 v35, 7, v48
    v_lshlrev_b32 v36, 4, v4
    v_add_u32 v35, v35, v36
    v_bfe_u32 v50, v0, 2, 2
    v_lshlrev_b32 v51, 3, v4
    v_add_u32 v50, v50, v51
    v_mul_u32_u24 v50, 896, v50
    v_lshlrev_b32 v51, 3, v48
    v_add_u32 v50, v50, v51
    v_add_u32 v51, 28672, v50
    v_mul_u32_u24 v44, 100352, v4
    v_bfe_u32 v45, v0, 3, 1
    v_mul_u32_u24 v45, 1792, v45
    v_add_u32 v44, v44, v45
    v_and_b32 v45, 7, v0
    v_lshlrev_b32 v45, 3, v45
    v_add_u32 v44, v44, v45
    s_lshl_b32 s12, s14, 6
    s_add_u32 s12, s12, 196608
    s_waitcnt lgkmcnt(0)
    ds_read_b128 v[56:59], v35 offset:5696
    ds_read_b128 v[60:63], v35 offset:5760
    s_waitcnt lgkmcnt(0)
    ds_read_b64_tr_b16 v[64:65], v50 offset:8192
    ds_read_b64_tr_b16 v[66:67], v50 offset:11776
    ds_read_b64_tr_b16 v[68:69], v51 offset:8192
    ds_read_b64_tr_b16 v[70:71], v51 offset:11776
    ds_read_b64_tr_b16 v[72:73], v50 offset:8224
    ds_read_b64_tr_b16 v[74:75], v50 offset:11808
    ds_read_b64_tr_b16 v[76:77], v51 offset:8224
    ds_read_b64_tr_b16 v[78:79], v51 offset:11808
    ds_read_b64_tr_b16 v[80:81], v50 offset:8256
    ds_read_b64_tr_b16 v[82:83], v50 offset:11840
    ds_read_b64_tr_b16 v[84:85], v51 offset:8256
    ds_read_b64_tr_b16 v[86:87], v51 offset:11840
    s_waitcnt lgkmcnt(0)
    v_mfma_f32_16x16x32_bf16 v[96:99], v[56:59], v[64:67], 0
    v_mfma_f32_16x16x32_bf16 v[96:99], v[60:63], v[68:71], v[96:99]
    v_mfma_f32_16x16x32_bf16 v[100:103], v[56:59], v[72:75], 0
    v_mfma_f32_16x16x32_bf16 v[100:103], v[60:63], v[76:79], v[100:103]
    v_mfma_f32_16x16x32_bf16 v[104:107], v[56:59], v[80:83], 0
    v_mfma_f32_16x16x32_bf16 v[104:107], v[60:63], v[84:87], v[104:107]
    s_nop 3
    v_cndmask_b32 v112, v96, v97, s[74:75]
    v_cndmask_b32 v112, v112, v98, s[76:77]
    v_cndmask_b32 v112, v112, v99, s[78:79]
    v_mov_b32 v113, s10
    buffer_store_dwordx2 v[112:113], v44, s[40:43], s12 offen sc1
    s_add_u32 s12, s12, 3584
    v_cndmask_b32 v114, v100, v101, s[74:75]
    v_cndmask_b32 v114, v114, v102, s[76:77]
    v_cndmask_b32 v114, v114, v103, s[78:79]
    v_mov_b32 v115, s10
    buffer_store_dwordx2 v[114:115], v44, s[40:43], s12 offen sc1
    s_add_u32 s12, s12, 3584
    v_cndmask_b32 v116, v104, v105, s[74:75]
    v_cndmask_b32 v116, v116, v106, s[76:77]
    v_cndmask_b32 v116, v116, v107, s[78:79]
    v_mov_b32 v117, s10
    buffer_store_dwordx2 v[116:117], v44, s[40:43], s12 offen sc1
    s_add_u32 s12, s12, 3584
    s_waitcnt lgkmcnt(0)
    ds_read_b64_tr_b16 v[64:65], v50 offset:8288
    ds_read_b64_tr_b16 v[66:67], v50 offset:11872
    ds_read_b64_tr_b16 v[68:69], v51 offset:8288
    ds_read_b64_tr_b16 v[70:71], v51 offset:11872
    ds_read_b64_tr_b16 v[72:73], v50 offset:8320
    ds_read_b64_tr_b16 v[74:75], v50 offset:11904
    ds_read_b64_tr_b16 v[76:77], v51 offset:8320
    ds_read_b64_tr_b16 v[78:79], v51 offset:11904
    ds_read_b64_tr_b16 v[80:81], v50 offset:8352
    ds_read_b64_tr_b16 v[82:83], v50 offset:11936
    ds_read_b64_tr_b16 v[84:85], v51 offset:8352
    ds_read_b64_tr_b16 v[86:87], v51 offset:11936
    s_waitcnt lgkmcnt(0)
    v_mfma_f32_16x16x32_bf16 v[96:99], v[56:59], v[64:67], 0
    v_mfma_f32_16x16x32_bf16 v[96:99], v[60:63], v[68:71], v[96:99]
    v_mfma_f32_16x16x32_bf16 v[100:103], v[56:59], v[72:75], 0
    v_mfma_f32_16x16x32_bf16 v[100:103], v[60:63], v[76:79], v[100:103]
    v_mfma_f32_16x16x32_bf16 v[104:107], v[56:59], v[80:83], 0
    v_mfma_f32_16x16x32_bf16 v[104:107], v[60:63], v[84:87], v[104:107]
    s_nop 3
    v_cndmask_b32 v112, v96, v97, s[74:75]
    v_cndmask_b32 v112, v112, v98, s[76:77]
    v_cndmask_b32 v112, v112, v99, s[78:79]
    v_mov_b32 v113, s10
    buffer_store_dwordx2 v[112:113], v44, s[40:43], s12 offen sc1
    s_add_u32 s12, s12, 3584
    v_cndmask_b32 v114, v100, v101, s[74:75]
    v_cndmask_b32 v114, v114, v102, s[76:77]
    v_cndmask_b32 v114, v114, v103, s[78:79]
    v_mov_b32 v115, s10
    buffer_store_dwordx2 v[114:115], v44, s[40:43], s12 offen sc1
    s_add_u32 s12, s12, 3584
    v_cndmask_b32 v116, v104, v105, s[74:75]
    v_cndmask_b32 v116, v116, v106, s[76:77]
    v_cndmask_b32 v116, v116, v107, s[78:79]
    v_mov_b32 v117, s10
    buffer_store_dwordx2 v[116:117], v44, s[40:43], s12 offen sc1
    s_add_u32 s12, s12, 3584
    s_waitcnt lgkmcnt(0)
    ds_read_b64_tr_b16 v[64:65], v50 offset:8384
    ds_read_b64_tr_b16 v[66:67], v50 offset:11968
    ds_read_b64_tr_b16 v[68:69], v51 offset:8384
    ds_read_b64_tr_b16 v[70:71], v51 offset:11968
    ds_read_b64_tr_b16 v[72:73], v50 offset:8416
    ds_read_b64_tr_b16 v[74:75], v50 offset:12000
    ds_read_b64_tr_b16 v[76:77], v51 offset:8416
    ds_read_b64_tr_b16 v[78:79], v51 offset:12000
    ds_read_b64_tr_b16 v[80:81], v50 offset:8448
    ds_read_b64_tr_b16 v[82:83], v50 offset:12032
    ds_read_b64_tr_b16 v[84:85], v51 offset:8448
    ds_read_b64_tr_b16 v[86:87], v51 offset:12032
    s_waitcnt lgkmcnt(0)
    v_mfma_f32_16x16x32_bf16 v[96:99], v[56:59], v[64:67], 0
    v_mfma_f32_16x16x32_bf16 v[96:99], v[60:63], v[68:71], v[96:99]
    v_mfma_f32_16x16x32_bf16 v[100:103], v[56:59], v[72:75], 0
    v_mfma_f32_16x16x32_bf16 v[100:103], v[60:63], v[76:79], v[100:103]
    v_mfma_f32_16x16x32_bf16 v[104:107], v[56:59], v[80:83], 0
    v_mfma_f32_16x16x32_bf16 v[104:107], v[60:63], v[84:87], v[104:107]
    s_nop 3
    v_cndmask_b32 v112, v96, v97, s[74:75]
    v_cndmask_b32 v112, v112, v98, s[76:77]
    v_cndmask_b32 v112, v112, v99, s[78:79]
    v_mov_b32 v113, s10
    buffer_store_dwordx2 v[112:113], v44, s[40:43], s12 offen sc1
    s_add_u32 s12, s12, 3584
    v_cndmask_b32 v114, v100, v101, s[74:75]
    v_cndmask_b32 v114, v114, v102, s[76:77]
    v_cndmask_b32 v114, v114, v103, s[78:79]
    v_mov_b32 v115, s10
    buffer_store_dwordx2 v[114:115], v44, s[40:43], s12 offen sc1
    s_add_u32 s12, s12, 3584
    v_cndmask_b32 v116, v104, v105, s[74:75]
    v_cndmask_b32 v116, v116, v106, s[76:77]
    v_cndmask_b32 v116, v116, v107, s[78:79]
    v_mov_b32 v117, s10
    buffer_store_dwordx2 v[116:117], v44, s[40:43], s12 offen sc1
    s_add_u32 s12, s12, 3584
    s_waitcnt lgkmcnt(0)
    ds_read_b64_tr_b16 v[64:65], v50 offset:8480
    ds_read_b64_tr_b16 v[66:67], v50 offset:12064
    ds_read_b64_tr_b16 v[68:69], v51 offset:8480
    ds_read_b64_tr_b16 v[70:71], v51 offset:12064
    ds_read_b64_tr_b16 v[72:73], v50 offset:8512
    ds_read_b64_tr_b16 v[74:75], v50 offset:12096
    ds_read_b64_tr_b16 v[76:77], v51 offset:8512
    ds_read_b64_tr_b16 v[78:79], v51 offset:12096
    ds_read_b64_tr_b16 v[80:81], v50 offset:8544
    ds_read_b64_tr_b16 v[82:83], v50 offset:12128
    ds_read_b64_tr_b16 v[84:85], v51 offset:8544
    ds_read_b64_tr_b16 v[86:87], v51 offset:12128
    s_waitcnt lgkmcnt(0)
    v_mfma_f32_16x16x32_bf16 v[96:99], v[56:59], v[64:67], 0
    v_mfma_f32_16x16x32_bf16 v[96:99], v[60:63], v[68:71], v[96:99]
    v_mfma_f32_16x16x32_bf16 v[100:103], v[56:59], v[72:75], 0
    v_mfma_f32_16x16x32_bf16 v[100:103], v[60:63], v[76:79], v[100:103]
    v_mfma_f32_16x16x32_bf16 v[104:107], v[56:59], v[80:83], 0
    v_mfma_f32_16x16x32_bf16 v[104:107], v[60:63], v[84:87], v[104:107]
    s_nop 3
    v_cndmask_b32 v112, v96, v97, s[74:75]
    v_cndmask_b32 v112, v112, v98, s[76:77]
    v_cndmask_b32 v112, v112, v99, s[78:79]
    v_mov_b32 v113, s10
    buffer_store_dwordx2 v[112:113], v44, s[40:43], s12 offen sc1
    s_add_u32 s12, s12, 3584
    v_cndmask_b32 v114, v100, v101, s[74:75]
    v_cndmask_b32 v114, v114, v102, s[76:77]
    v_cndmask_b32 v114, v114, v103, s[78:79]
    v_mov_b32 v115, s10
    buffer_store_dwordx2 v[114:115], v44, s[40:43], s12 offen sc1
    s_add_u32 s12, s12, 3584
    v_cndmask_b32 v116, v104, v105, s[74:75]
    v_cndmask_b32 v116, v116, v106, s[76:77]
    v_cndmask_b32 v116, v116, v107, s[78:79]
    v_mov_b32 v117, s10
    buffer_store_dwordx2 v[116:117], v44, s[40:43], s12 offen sc1
    s_add_u32 s12, s12, 3584
    s_waitcnt lgkmcnt(0)
    ds_read_b64_tr_b16 v[64:65], v50 offset:8576
    ds_read_b64_tr_b16 v[66:67], v50 offset:12160
    ds_read_b64_tr_b16 v[68:69], v51 offset:8576
    ds_read_b64_tr_b16 v[70:71], v51 offset:12160
    ds_read_b64_tr_b16 v[72:73], v50 offset:8608
    ds_read_b64_tr_b16 v[74:75], v50 offset:12192
    ds_read_b64_tr_b16 v[76:77], v51 offset:8608
    ds_read_b64_tr_b16 v[78:79], v51 offset:12192
    ds_read_b64_tr_b16 v[80:81], v50 offset:8640
    ds_read_b64_tr_b16 v[82:83], v50 offset:12224
    ds_read_b64_tr_b16 v[84:85], v51 offset:8640
    ds_read_b64_tr_b16 v[86:87], v51 offset:12224
    s_waitcnt lgkmcnt(0)
    v_mfma_f32_16x16x32_bf16 v[96:99], v[56:59], v[64:67], 0
    v_mfma_f32_16x16x32_bf16 v[96:99], v[60:63], v[68:71], v[96:99]
    v_mfma_f32_16x16x32_bf16 v[100:103], v[56:59], v[72:75], 0
    v_mfma_f32_16x16x32_bf16 v[100:103], v[60:63], v[76:79], v[100:103]
    v_mfma_f32_16x16x32_bf16 v[104:107], v[56:59], v[80:83], 0
    v_mfma_f32_16x16x32_bf16 v[104:107], v[60:63], v[84:87], v[104:107]
    s_nop 3
    v_cndmask_b32 v112, v96, v97, s[74:75]
    v_cndmask_b32 v112, v112, v98, s[76:77]
    v_cndmask_b32 v112, v112, v99, s[78:79]
    v_mov_b32 v113, s10
    buffer_store_dwordx2 v[112:113], v44, s[40:43], s12 offen sc1
    s_add_u32 s12, s12, 3584
    v_cndmask_b32 v114, v100, v101, s[74:75]
    v_cndmask_b32 v114, v114, v102, s[76:77]
    v_cndmask_b32 v114, v114, v103, s[78:79]
    v_mov_b32 v115, s10
    buffer_store_dwordx2 v[114:115], v44, s[40:43], s12 offen sc1
    s_add_u32 s12, s12, 3584
    v_cndmask_b32 v116, v104, v105, s[74:75]
    v_cndmask_b32 v116, v116, v106, s[76:77]
    v_cndmask_b32 v116, v116, v107, s[78:79]
    v_mov_b32 v117, s10
    buffer_store_dwordx2 v[116:117], v44, s[40:43], s12 offen sc1
    s_add_u32 s12, s12, 3584
    s_waitcnt lgkmcnt(0)
    ds_read_b64_tr_b16 v[64:65], v50 offset:8672
    ds_read_b64_tr_b16 v[66:67], v50 offset:12256
    ds_read_b64_tr_b16 v[68:69], v51 offset:8672
    ds_read_b64_tr_b16 v[70:71], v51 offset:12256
    ds_read_b64_tr_b16 v[72:73], v50 offset:8704
    ds_read_b64_tr_b16 v[74:75], v50 offset:12288
    ds_read_b64_tr_b16 v[76:77], v51 offset:8704
    ds_read_b64_tr_b16 v[78:79], v51 offset:12288
    ds_read_b64_tr_b16 v[80:81], v50 offset:8736
    ds_read_b64_tr_b16 v[82:83], v50 offset:12320
    ds_read_b64_tr_b16 v[84:85], v51 offset:8736
    ds_read_b64_tr_b16 v[86:87], v51 offset:12320
    s_waitcnt lgkmcnt(0)
    v_mfma_f32_16x16x32_bf16 v[96:99], v[56:59], v[64:67], 0
    v_mfma_f32_16x16x32_bf16 v[96:99], v[60:63], v[68:71], v[96:99]
    v_mfma_f32_16x16x32_bf16 v[100:103], v[56:59], v[72:75], 0
    v_mfma_f32_16x16x32_bf16 v[100:103], v[60:63], v[76:79], v[100:103]
    v_mfma_f32_16x16x32_bf16 v[104:107], v[56:59], v[80:83], 0
    v_mfma_f32_16x16x32_bf16 v[104:107], v[60:63], v[84:87], v[104:107]
    s_nop 3
    v_cndmask_b32 v112, v96, v97, s[74:75]
    v_cndmask_b32 v112, v112, v98, s[76:77]
    v_cndmask_b32 v112, v112, v99, s[78:79]
    v_mov_b32 v113, s10
    buffer_store_dwordx2 v[112:113], v44, s[40:43], s12 offen sc1
    s_add_u32 s12, s12, 3584
    v_cndmask_b32 v114, v100, v101, s[74:75]
    v_cndmask_b32 v114, v114, v102, s[76:77]
    v_cndmask_b32 v114, v114, v103, s[78:79]
    v_mov_b32 v115, s10
    buffer_store_dwordx2 v[114:115], v44, s[40:43], s12 offen sc1
    s_add_u32 s12, s12, 3584
    v_cndmask_b32 v116, v104, v105, s[74:75]
    v_cndmask_b32 v116, v116, v106, s[76:77]
    v_cndmask_b32 v116, v116, v107, s[78:79]
    v_mov_b32 v117, s10
    buffer_store_dwordx2 v[116:117], v44, s[40:43], s12 offen sc1
    s_add_u32 s12, s12, 3584
    s_waitcnt lgkmcnt(0)
    ds_read_b64_tr_b16 v[64:65], v50 offset:8768
    ds_read_b64_tr_b16 v[66:67], v50 offset:12352
    ds_read_b64_tr_b16 v[68:69], v51 offset:8768
    ds_read_b64_tr_b16 v[70:71], v51 offset:12352
    ds_read_b64_tr_b16 v[72:73], v50 offset:8800
    ds_read_b64_tr_b16 v[74:75], v50 offset:12384
    ds_read_b64_tr_b16 v[76:77], v51 offset:8800
    ds_read_b64_tr_b16 v[78:79], v51 offset:12384
    ds_read_b64_tr_b16 v[80:81], v50 offset:8832
    ds_read_b64_tr_b16 v[82:83], v50 offset:12416
    ds_read_b64_tr_b16 v[84:85], v51 offset:8832
    ds_read_b64_tr_b16 v[86:87], v51 offset:12416
    s_waitcnt lgkmcnt(0)
    v_mfma_f32_16x16x32_bf16 v[96:99], v[56:59], v[64:67], 0
    v_mfma_f32_16x16x32_bf16 v[96:99], v[60:63], v[68:71], v[96:99]
    v_mfma_f32_16x16x32_bf16 v[100:103], v[56:59], v[72:75], 0
    v_mfma_f32_16x16x32_bf16 v[100:103], v[60:63], v[76:79], v[100:103]
    v_mfma_f32_16x16x32_bf16 v[104:107], v[56:59], v[80:83], 0
    v_mfma_f32_16x16x32_bf16 v[104:107], v[60:63], v[84:87], v[104:107]
    s_nop 3
    v_cndmask_b32 v112, v96, v97, s[74:75]
    v_cndmask_b32 v112, v112, v98, s[76:77]
    v_cndmask_b32 v112, v112, v99, s[78:79]
    v_mov_b32 v113, s10
    buffer_store_dwordx2 v[112:113], v44, s[40:43], s12 offen sc1
    s_add_u32 s12, s12, 3584
    v_cndmask_b32 v114, v100, v101, s[74:75]
    v_cndmask_b32 v114, v114, v102, s[76:77]
    v_cndmask_b32 v114, v114, v103, s[78:79]
    v_mov_b32 v115, s10
    buffer_store_dwordx2 v[114:115], v44, s[40:43], s12 offen sc1
    s_add_u32 s12, s12, 3584
    v_cndmask_b32 v116, v104, v105, s[74:75]
    v_cndmask_b32 v116, v116, v106, s[76:77]
    v_cndmask_b32 v116, v116, v107, s[78:79]
    v_mov_b32 v117, s10
    buffer_store_dwordx2 v[116:117], v44, s[40:43], s12 offen sc1
    s_add_u32 s12, s12, 3584
    s_waitcnt lgkmcnt(0)
    ds_read_b64_tr_b16 v[64:65], v50 offset:8864
    ds_read_b64_tr_b16 v[66:67], v50 offset:12448
    ds_read_b64_tr_b16 v[68:69], v51 offset:8864
    ds_read_b64_tr_b16 v[70:71], v51 offset:12448
    ds_read_b64_tr_b16 v[72:73], v50 offset:8896
    ds_read_b64_tr_b16 v[74:75], v50 offset:12480
    ds_read_b64_tr_b16 v[76:77], v51 offset:8896
    ds_read_b64_tr_b16 v[78:79], v51 offset:12480
    ds_read_b64_tr_b16 v[80:81], v50 offset:8928
    ds_read_b64_tr_b16 v[82:83], v50 offset:12512
    ds_read_b64_tr_b16 v[84:85], v51 offset:8928
    ds_read_b64_tr_b16 v[86:87], v51 offset:12512
    s_waitcnt lgkmcnt(0)
    v_mfma_f32_16x16x32_bf16 v[96:99], v[56:59], v[64:67], 0
    v_mfma_f32_16x16x32_bf16 v[96:99], v[60:63], v[68:71], v[96:99]
    v_mfma_f32_16x16x32_bf16 v[100:103], v[56:59], v[72:75], 0
    v_mfma_f32_16x16x32_bf16 v[100:103], v[60:63], v[76:79], v[100:103]
    v_mfma_f32_16x16x32_bf16 v[104:107], v[56:59], v[80:83], 0
    v_mfma_f32_16x16x32_bf16 v[104:107], v[60:63], v[84:87], v[104:107]
    s_nop 3
    v_cndmask_b32 v112, v96, v97, s[74:75]
    v_cndmask_b32 v112, v112, v98, s[76:77]
    v_cndmask_b32 v112, v112, v99, s[78:79]
    v_mov_b32 v113, s10
    buffer_store_dwordx2 v[112:113], v44, s[40:43], s12 offen sc1
    s_add_u32 s12, s12, 3584
    v_cndmask_b32 v114, v100, v101, s[74:75]
    v_cndmask_b32 v114, v114, v102, s[76:77]
    v_cndmask_b32 v114, v114, v103, s[78:79]
    v_mov_b32 v115, s10
    buffer_store_dwordx2 v[114:115], v44, s[40:43], s12 offen sc1
    s_add_u32 s12, s12, 3584
    v_cndmask_b32 v116, v104, v105, s[74:75]
    v_cndmask_b32 v116, v116, v106, s[76:77]
    v_cndmask_b32 v116, v116, v107, s[78:79]
    v_mov_b32 v117, s10
    buffer_store_dwordx2 v[116:117], v44, s[40:43], s12 offen sc1
    s_add_u32 s12, s12, 3584
    s_waitcnt lgkmcnt(0)
    ds_read_b64_tr_b16 v[64:65], v50 offset:8960
    ds_read_b64_tr_b16 v[66:67], v50 offset:12544
    ds_read_b64_tr_b16 v[68:69], v51 offset:8960
    ds_read_b64_tr_b16 v[70:71], v51 offset:12544
    ds_read_b64_tr_b16 v[72:73], v50 offset:8992
    ds_read_b64_tr_b16 v[74:75], v50 offset:12576
    ds_read_b64_tr_b16 v[76:77], v51 offset:8992
    ds_read_b64_tr_b16 v[78:79], v51 offset:12576
    ds_read_b64_tr_b16 v[80:81], v50 offset:9024
    ds_read_b64_tr_b16 v[82:83], v50 offset:12608
    ds_read_b64_tr_b16 v[84:85], v51 offset:9024
    ds_read_b64_tr_b16 v[86:87], v51 offset:12608
    s_waitcnt lgkmcnt(0)
    v_mfma_f32_16x16x32_bf16 v[96:99], v[56:59], v[64:67], 0
    v_mfma_f32_16x16x32_bf16 v[96:99], v[60:63], v[68:71], v[96:99]
    v_mfma_f32_16x16x32_bf16 v[100:103], v[56:59], v[72:75], 0
    v_mfma_f32_16x16x32_bf16 v[100:103], v[60:63], v[76:79], v[100:103]
    v_mfma_f32_16x16x32_bf16 v[104:107], v[56:59], v[80:83], 0
    v_mfma_f32_16x16x32_bf16 v[104:107], v[60:63], v[84:87], v[104:107]
    s_nop 3
    v_cndmask_b32 v112, v96, v97, s[74:75]
    v_cndmask_b32 v112, v112, v98, s[76:77]
    v_cndmask_b32 v112, v112, v99, s[78:79]
    v_mov_b32 v113, s10
    buffer_store_dwordx2 v[112:113], v44, s[40:43], s12 offen sc1
    s_add_u32 s12, s12, 3584
    v_cndmask_b32 v114, v100, v101, s[74:75]
    v_cndmask_b32 v114, v114, v102, s[76:77]
    v_cndmask_b32 v114, v114, v103, s[78:79]
    v_mov_b32 v115, s10
    buffer_store_dwordx2 v[114:115], v44, s[40:43], s12 offen sc1
    s_add_u32 s12, s12, 3584
    v_cndmask_b32 v116, v104, v105, s[74:75]
    v_cndmask_b32 v116, v116, v106, s[76:77]
    v_cndmask_b32 v116, v116, v107, s[78:79]
    v_mov_b32 v117, s10
    buffer_store_dwordx2 v[116:117], v44, s[40:43], s12 offen sc1
    s_add_u32 s12, s12, 3584
    s_waitcnt lgkmcnt(0)
    ds_read_b64_tr_b16 v[64:65], v50 offset:9056
    ds_read_b64_tr_b16 v[66:67], v50 offset:12640
    ds_read_b64_tr_b16 v[68:69], v51 offset:9056
    ds_read_b64_tr_b16 v[70:71], v51 offset:12640
    s_waitcnt lgkmcnt(0)
    v_mfma_f32_16x16x32_bf16 v[96:99], v[56:59], v[64:67], 0
    v_mfma_f32_16x16x32_bf16 v[96:99], v[60:63], v[68:71], v[96:99]
    s_nop 7
    v_cndmask_b32 v112, v96, v97, s[74:75]
    v_cndmask_b32 v112, v112, v98, s[76:77]
    v_cndmask_b32 v112, v112, v99, s[78:79]
    v_mov_b32 v113, s10
    buffer_store_dwordx2 v[112:113], v44, s[40:43], s12 offen sc1
    s_add_u32 s12, s12, 3584
L_nod1:
    s_mov_b32 s52, s24
    s_mov_b32 s53, s25
    s_mov_b32 s54, 3670016
    s_mov_b32 s55, 0x20000
    v_lshrrev_b32 v4, 4, v0
    v_and_b32 v6, 7, v0
    v_bfe_u32 v7, v0, 3, 1
    v_mul_u32_u24 v3, 7168, v4
    v_lshl_add_u32 v3, v6, 4, v3
    v_mul_u32_u24 v8, 229376, v7
    v_add_u32 v3, v3, v8
    s_lshl_b32 s73, s4, 9
    s_lshl_b32 s12, s7, 5
    s_add_u32 s73, s73, s12
    s_mul_i32 s73, s73, 896
    buffer_load_dwordx4 v[100:103], v3, s[52:55], s73 offen offset:768
    s_add_u32 s73, s73, 896
    buffer_load_dwordx4 v[104:107], v3, s[52:55], s73 offen offset:768
    s_add_u32 s73, s73, 896
    buffer_load_dwordx4 v[108:111], v3, s[52:55], s73 offen offset:768
    s_add_u32 s73, s73, 896
    buffer_load_dwordx4 v[112:115], v3, s[52:55], s73 offen offset:768
    s_add_u32 s73, s73, 896
    buffer_load_dwordx4 v[116:119], v3, s[52:55], s73 offen offset:768
    s_add_u32 s73, s73, 896
    buffer_load_dwordx4 v[120:123], v3, s[52:55], s73 offen offset:768
    s_add_u32 s73, s73, 896
    buffer_load_dwordx4 v[124:127], v3, s[52:55], s73 offen offset:768
    s_add_u32 s73, s73, 896
    buffer_load_dwordx4 v[128:131], v3, s[52:55], s73 offen offset:768
    v_bfe_u32 v8, v0, 2, 1
    v_lshl_add_u32 v8, v4, 1, v8
    v_and_b32 v10, 3, v0
    v_lshl_add_u32 v10, v7, 2, v10
    v_lshlrev_b32 v5, 8, v8
    v_lshl_add_u32 v5, v10, 5, v5
    v_lshlrev_b32 v42, 5, v10
    v_lshl_add_u32 v42, v8, 2, v42
    v_lshlrev_b32 v43, 7, v7
    v_lshl_add_u32 v43, v4, 5, v43
    s_lshl_b32 s71, s2, 11
    s_add_u32 s71, s71, 1048576
    s_xor_b32 s71, s71, s81
    v_lshlrev_b32 v9, 11, v6
    v_bfe_u32 v8, v0, 4, 1
    v_lshl_add_u32 v9, v8, 4, v9
    v_xor_b32 v9, s81, v9
    s_lshl_b32 s73, s6, 17
    s_lshl_b32 s12, s9, 5
    s_add_u32 s73, s73, s12
    s_add_u32 s73, s73, 1671168
    v_and_b32 v8, 1, v0
    v_mov_b32 v10, 0xffff
    v_mov_b32 v11, 0xffff0000
    v_cmp_eq_u32 vcc, 1, v8
    s_nop 1
    v_cndmask_b32 v10, v10, v11, vcc
    v_bfe_u32 v8, v0, 1, 2
    v_cmp_eq_u32 vcc, 0, v8
    s_nop 1
    v_cndmask_b32 v12, 0, v10, vcc
    v_cmp_eq_u32 vcc, 1, v8
    s_nop 1
    v_cndmask_b32 v13, 0, v10, vcc
    v_cmp_eq_u32 vcc, 2, v8
    s_nop 1
    v_cndmask_b32 v14, 0, v10, vcc
    v_cmp_eq_u32 vcc, 3, v8
    s_nop 1
    v_cndmask_b32 v15, 0, v10, vcc
    s_mov_b32 s64, s34
    s_mov_b32 s65, s35
    s_mov_b32 s66, 3584
    s_mov_b32 s67, 0x20000
    v_and_b32 v34, 1, v0
    v_lshlrev_b32 v60, 3, v34
    v_mov_b32 v61, 0
    s_mul_i32 s70, s6, 896
    s_lshl_b32 s13, s9, 4
    s_add_u32 s70, s70, s13
    s_mov_b32 s60, 720896
    v_lshlrev_b32 v35, 5, v0
    s_min_u32 s13, s9, 55
    s_mul_i32 s61, s6, 56
    s_add_u32 s61, s61, s13
    s_mul_i32 s61, s61, 1792
    s_add_u32 s61, s61, 196608
    s_lshl_b32 s62, s8, 10
    s_add_u32 s62, s62, 655360
    v_mov_b32 v16, 0
    v_mov_b32 v17, 0
    v_mov_b32 v18, 0
    v_mov_b32 v19, 0
    v_mov_b32 v20, 0
    v_mov_b32 v21, 0
    v_mov_b32 v22, 0
    v_mov_b32 v23, 0
    v_mov_b32 v44, 0xff800000
    v_mov_b32 v46, 0
    v_mov_b32 v41, 5120
L_hl:
    ds_read_b32 v40, v41 offset:12
    s_waitcnt lgkmcnt(0)
    v_cmp_eq_u32 vcc, 0, v40
    s_nop 1
    s_cbranch_vccz L_hl_ok
    s_sleep 4
    s_branch L_hl
L_hl_ok:
    buffer_load_dwordx2 v[62:63], v60, s[44:47], s70 offen
    buffer_load_dwordx4 v[28:31], v1, s[40:43], s60 offen sc1
    s_mov_b32 exec_hi, 0x00ffffff
    buffer_load_dwordx4 v[16:19], v35, s[40:43], s61 offen sc1
    buffer_load_dwordx4 v[20:23], v35, s[40:43], s61 offen offset:16 sc1
    s_mov_b32 exec_lo, 0x3f3f3f3f
    s_mov_b32 exec_hi, 0x3f3f3f3f
    buffer_load_dwordx4 v[44:47], v1, s[40:43], s62 offen sc1
    s_mov_b64 exec, -1
    s_waitcnt vmcnt(0)
    s_mov_b32 exec_lo, 0x3f3f3f3f
    s_mov_b32 exec_hi, 0x3f3f3f3f
    s_mov_b32 s11, 200000
    s_branch L_chk9
L_poll9:
    buffer_load_dwordx4 v[44:47], v1, s[40:43], s62 offen sc1
    s_waitcnt vmcnt(0)
L_chk9:
    v_xor_b32 v36, s10, v45
    v_xor_b32 v37, s10, v47
    v_or_b32 v36, v36, v37
    v_cmp_ne_u32 vcc, 0, v36
    s_nop 1
    s_cbranch_vccz L_done9
    s_mov_b64 exec, vcc
    s_sub_u32 s11, s11, 1
    s_cbranch_scc1 L_done9
    s_sleep 32
    s_branch L_poll9
L_done9:
    s_mov_b64 exec, s[0:1]
    v_mov_b32 v36, v44
    s_nop 1
    v_max_f32_dpp v36, v36, v36 quad_perm:[2,3,0,1] row_mask:0xf bank_mask:0xf
    s_nop 1
    v_max_f32_dpp v36, v36, v36 row_ror:4 row_mask:0xf bank_mask:0xf
    s_nop 1
    v_max_f32_dpp v36, v36, v36 row_ror:8 row_mask:0xf bank_mask:0xf
    v_mov_b32 v37, v36
    s_nop 1
    v_permlane16_swap_b32 v36, v37
    v_max_f32 v36, v36, v37
    v_mov_b32 v37, v36
    s_nop 1
    v_permlane32_swap_b32 v36, v37
    v_max_f32 v36, v36, v37
    s_mov_b32 s13, 1035512379
    v_sub_f32 v37, v44, v36
    v_mul_f32 v37, s13, v37
    v_exp_f32 v37, v37
    s_nop 0
    v_mul_f32 v37, v37, v46
    s_nop 1
    v_add_f32_dpp v37, v37, v37 quad_perm:[2,3,0,1] row_mask:0xf bank_mask:0xf
    s_nop 1
    v_add_f32_dpp v37, v37, v37 row_ror:4 row_mask:0xf bank_mask:0xf
    s_nop 1
    v_add_f32_dpp v37, v37, v37 row_ror:8 row_mask:0xf bank_mask:0xf
    v_mov_b32 v38, v37
    s_nop 1
    v_permlane16_swap_b32 v37, v38
    v_add_f32 v37, v37, v38
    v_mov_b32 v38, v37
    s_nop 1
    v_permlane32_swap_b32 v37, v38
    v_add_f32 v37, v37, v38
    v_rcp_f32 v37, v37
    v_and_b32 v38, 1, v0
    v_lshlrev_b32 v38, 2, v38
    v_add_u32 v38, 5184, v38
    ds_write2_b32 v38, v36, v37 offset0:0 offset1:2
    s_waitcnt lgkmcnt(0)
    v_mov_b32 v38, 5184
    v_mov_b32 v39, 1
    ds_write_b32 v38, v39 offset:16
    s_mov_b32 s11, 200000
    s_branch L_chk10
L_poll10:
    buffer_load_dwordx4 v[28:31], v1, s[40:43], s60 offen sc1
    s_waitcnt vmcnt(0)
L_chk10:
    v_xor_b32 v24, s10, v28
    v_xor_b32 v25, s10, v29
    v_xor_b32 v26, s10, v30
    v_xor_b32 v27, s10, v31
    v_or3_b32 v24, v24, v25, v26
    v_or_b32 v24, v24, v27
    v_cmp_ne_u32 vcc, 0, v24
    s_nop 1
    s_cbranch_vccz L_done10
    s_mov_b64 exec, vcc
    s_sub_u32 s11, s11, 1
    s_cbranch_scc1 L_done10
    s_sleep 32
    s_branch L_poll10
L_done10:
    s_mov_b64 exec, s[0:1]
    s_mov_b32 exec_hi, 0x00ffffff
    s_mov_b32 s11, 200000
    s_branch L_chk11
L_poll11:
    buffer_load_dwordx4 v[16:19], v35, s[40:43], s61 offen sc1
    buffer_load_dwordx4 v[20:23], v35, s[40:43], s61 offen offset:16 sc1
    s_waitcnt vmcnt(0)
L_chk11:
    v_xor_b32 v24, s10, v17
    v_xor_b32 v25, s10, v19
    v_xor_b32 v26, s10, v21
    v_xor_b32 v27, s10, v23
    v_or3_b32 v24, v24, v25, v26
    v_or_b32 v24, v24, v27
    v_cmp_ne_u32 vcc, 0, v24
    s_nop 1
    s_cbranch_vccz L_done11
    s_mov_b64 exec, vcc
    s_sub_u32 s11, s11, 1
    s_cbranch_scc1 L_done11
    s_sleep 32
    s_branch L_poll11
L_done11:
    s_mov_b64 exec, s[0:1]
    v_add_f32_dpp v16, v16, v16 quad_perm:[2,3,0,1] row_mask:0xf bank_mask:0xf
    v_add_f32_dpp v18, v18, v18 quad_perm:[2,3,0,1] row_mask:0xf bank_mask:0xf
    v_add_f32_dpp v20, v20, v20 quad_perm:[2,3,0,1] row_mask:0xf bank_mask:0xf
    v_add_f32_dpp v22, v22, v22 quad_perm:[2,3,0,1] row_mask:0xf bank_mask:0xf
    v_add_f32_dpp v16, v16, v16 row_ror:4 row_mask:0xf bank_mask:0xf
    v_add_f32_dpp v18, v18, v18 row_ror:4 row_mask:0xf bank_mask:0xf
    v_add_f32_dpp v20, v20, v20 row_ror:4 row_mask:0xf bank_mask:0xf
    v_add_f32_dpp v22, v22, v22 row_ror:4 row_mask:0xf bank_mask:0xf
    v_add_f32_dpp v16, v16, v16 row_ror:8 row_mask:0xf bank_mask:0xf
    v_add_f32_dpp v18, v18, v18 row_ror:8 row_mask:0xf bank_mask:0xf
    v_add_f32_dpp v20, v20, v20 row_ror:8 row_mask:0xf bank_mask:0xf
    v_add_f32_dpp v22, v22, v22 row_ror:8 row_mask:0xf bank_mask:0xf
    v_mov_b32 v17, v16
    v_mov_b32 v19, v18
    v_mov_b32 v21, v20
    v_mov_b32 v23, v22
    v_permlane16_swap_b32 v16, v17
    v_permlane16_swap_b32 v18, v19
    v_permlane16_swap_b32 v20, v21
    v_permlane16_swap_b32 v22, v23
    v_add_f32 v16, v16, v17
    v_add_f32 v18, v18, v19
    v_add_f32 v20, v20, v21
    v_add_f32 v22, v22, v23
    v_mov_b32 v17, v16
    v_mov_b32 v19, v18
    v_mov_b32 v21, v20
    v_mov_b32 v23, v22
    v_permlane32_swap_b32 v16, v17
    v_permlane32_swap_b32 v18, v19
    v_permlane32_swap_b32 v20, v21
    v_permlane32_swap_b32 v22, v23
    v_add_f32 v16, v16, v17
    v_add_f32 v18, v18, v19
    v_add_f32 v20, v20, v21
    v_add_f32 v22, v22, v23
    s_mov_b32 s13, 3216550459
    v_cvt_pk_bf16_f32 v16, v16, v16
    v_and_b32 v16, 0xffff0000, v16
    v_cvt_pk_bf16_f32 v18, v18, v18
    v_and_b32 v18, 0xffff0000, v18
    v_cvt_pk_bf16_f32 v20, v20, v20
    v_and_b32 v20, 0xffff0000, v20
    v_cvt_pk_bf16_f32 v22, v22, v22
    v_and_b32 v22, 0xffff0000, v22
    v_mul_f32 v56, s13, v16
    v_mul_f32 v57, s13, v18
    v_mul_f32 v58, s13, v20
    v_mul_f32 v59, s13, v22
    v_exp_f32 v56, v56
    v_exp_f32 v57, v57
    v_exp_f32 v58, v58
    v_exp_f32 v59, v59
    v_add_f32 v56, 1.0, v56
    v_add_f32 v57, 1.0, v57
    v_add_f32 v58, 1.0, v58
    v_add_f32 v59, 1.0, v59
    v_rcp_f32 v56, v56
    v_rcp_f32 v57, v57
    v_rcp_f32 v58, v58
    v_rcp_f32 v59, v59
    v_mul_f32 v56, v16, v56
    v_mul_f32 v57, v18, v57
    v_mul_f32 v58, v20, v58
    v_mul_f32 v59, v22, v59
    v_cvt_pk_bf16_f32 v56, v56, v56
    v_and_b32 v56, 0xffff0000, v56
    v_cvt_pk_bf16_f32 v57, v57, v57
    v_and_b32 v57, 0xffff0000, v57
    v_cvt_pk_bf16_f32 v58, v58, v58
    v_and_b32 v58, 0xffff0000, v58
    v_cvt_pk_bf16_f32 v59, v59, v59
    v_and_b32 v59, 0xffff0000, v59
    v_lshlrev_b32 v52, 16, v62
    v_and_b32 v53, 0xffff0000, v62
    v_lshlrev_b32 v54, 16, v63
    v_and_b32 v55, 0xffff0000, v63
    s_mov_b32 s74, 0xffff0000
    s_mov_b32 s75, 0
    s_mov_b32 s76, 0
    s_mov_b32 s77, 0xffff
    s_mov_b32 s78, 0
    s_mov_b32 s79, 0xffff0000
    v_cndmask_b32 v24, v56, v57, s[74:75]
    v_cndmask_b32 v24, v24, v58, s[76:77]
    v_cndmask_b32 v24, v24, v59, s[78:79]
    v_cndmask_b32 v25, v52, v53, s[74:75]
    v_cndmask_b32 v25, v25, v54, s[76:77]
    v_cndmask_b32 v25, v25, v55, s[78:79]
    v_mov_b32 v57, v24
    v_mov_b32 v53, v25
    v_lshrrev_b32 v24, 4, v0
    v_lshl_add_u32 v59, v24, 1, v60
    v_mov_b32 v41, 5184
L_hpub:
    ds_read_b32 v40, v41 offset:24
    s_waitcnt lgkmcnt(0)
    v_cmp_eq_u32 vcc, 0, v40
    s_nop 1
    s_cbranch_vccz L_hpub_ok
    s_sleep 1
    s_branch L_hpub
L_hpub_ok:
    s_mov_b32 s11, 200000
L_poll12:
    buffer_load_dwordx4 v[64:67], v5, s[40:43], s71 offen sc1
    buffer_load_dwordx4 v[68:71], v5, s[40:43], s71 offen offset:16 sc1
    s_waitcnt vmcnt(0)
    v_max3_u32 v24, v64, v65, v66
    v_max3_u32 v25, v67, v68, v69
    v_max3_u32 v24, v24, v70, v71
    v_max_u32 v24, v24, v25
    v_cmp_eq_u32 vcc, -1, v24
    s_nop 1
    s_cbranch_vccz L_done12
    s_mov_b64 exec, vcc
    s_sub_u32 s11, s11, 1
    s_cbranch_scc1 L_done12
    s_branch L_poll12
L_done12:
    s_mov_b64 exec, s[0:1]
    v_permlane32_swap_b32 v64, v68
    v_permlane32_swap_b32 v65, v69
    v_permlane32_swap_b32 v66, v70
    v_permlane32_swap_b32 v67, v71
    v_pk_add_f32 v[64:65], v[64:65], v[68:69]
    v_pk_add_f32 v[66:67], v[66:67], v[70:71]
    s_nop 1
    v_permlane16_swap_b32 v64, v66
    v_permlane16_swap_b32 v65, v67
    v_pk_add_f32 v[64:65], v[64:65], v[66:67]
    s_nop 1
    v_add_f32_dpp v66, v64, v64 row_shl:4 row_mask:0xf bank_mask:0x5
    s_nop 1
    v_add_f32_dpp v66, v65, v65 row_shr:4 row_mask:0xf bank_mask:0xa
    v_cvt_pk_bf16_f32 v66, v66, v66
    ds_write_b32 v42, v66 offset:0
    s_waitcnt lgkmcnt(0)
    s_barrier
    ds_read_b128 v[64:67], v43 offset:0
    ds_read_b128 v[68:71], v43 offset:16
    s_waitcnt lgkmcnt(0)
    v_and_b32 v72, v12, v64
    v_and_b32 v73, v13, v64
    v_and_b32 v74, v14, v64
    v_and_b32 v75, v15, v64
    v_and_b32 v76, v12, v65
    v_and_b32 v77, v13, v65
    v_and_b32 v78, v14, v65
    v_and_b32 v79, v15, v65
    v_mfma_f32_16x16x32_bf16 v[88:91], v[72:75], v[100:103], 0
    v_and_b32 v80, v12, v66
    v_and_b32 v81, v13, v66
    v_and_b32 v82, v14, v66
    v_and_b32 v83, v15, v66
    v_mfma_f32_16x16x32_bf16 v[92:95], v[76:79], v[104:107], 0
    v_and_b32 v84, v12, v67
    v_and_b32 v85, v13, v67
    v_and_b32 v86, v14, v67
    v_and_b32 v87, v15, v67
    v_mfma_f32_16x16x32_bf16 v[88:91], v[80:83], v[108:111], v[88:91]
    v_and_b32 v72, v12, v68
    v_and_b32 v73, v13, v68
    v_and_b32 v74, v14, v68
    v_and_b32 v75, v15, v68
    v_mfma_f32_16x16x32_bf16 v[92:95], v[84:87], v[112:115], v[92:95]
    v_and_b32 v76, v12, v69
    v_and_b32 v77, v13, v69
    v_and_b32 v78, v14, v69
    v_and_b32 v79, v15, v69
    v_mfma_f32_16x16x32_bf16 v[88:91], v[72:75], v[116:119], v[88:91]
    v_and_b32 v80, v12, v70
    v_and_b32 v81, v13, v70
    v_and_b32 v82, v14, v70
    v_and_b32 v83, v15, v70
    v_mfma_f32_16x16x32_bf16 v[92:95], v[76:79], v[120:123], v[92:95]
    v_and_b32 v84, v12, v71
    v_and_b32 v85, v13, v71
    v_and_b32 v86, v14, v71
    v_and_b32 v87, v15, v71
    v_mfma_f32_16x16x32_bf16 v[88:91], v[80:83], v[124:127], v[88:91]
    s_nop 0
    v_mfma_f32_16x16x32_bf16 v[92:95], v[84:87], v[128:131], v[92:95]
    s_nop 7
    v_pk_add_f32 v[88:89], v[88:89], v[92:93]
    v_pk_add_f32 v[90:91], v[90:91], v[94:95]
    s_nop 0
    v_permlane32_swap_b32 v88, v92
    v_permlane32_swap_b32 v89, v93
    v_permlane32_swap_b32 v90, v94
    v_permlane32_swap_b32 v91, v95
    v_add_f32_dpp v88, v92, v88 row_ror:8 row_mask:0xf bank_mask:0xf
    v_add_f32_dpp v89, v93, v89 row_ror:8 row_mask:0xf bank_mask:0xf
    v_add_f32_dpp v90, v94, v90 row_ror:8 row_mask:0xf bank_mask:0xf
    v_add_f32_dpp v91, v95, v91 row_ror:8 row_mask:0xf bank_mask:0xf
    v_min_u32 v88, -2, v88
    v_min_u32 v89, -2, v89
    v_min_u32 v90, -2, v90
    v_min_u32 v91, -2, v91
    s_mov_b32 exec_lo, 0x00ff00ff
    s_mov_b32 exec_hi, 0
    buffer_store_dwordx4 v[88:91], v9, s[40:43], s73 offen sc1
    s_mov_b64 exec, -1
    s_cmp_ge_u32 s9, 56
    s_cbranch_scc1 L_fin
    s_sleep 15
    s_mov_b32 s11, 200000
L_poll13:
    buffer_load_dwordx4 v[16:19], v1, s[40:43], s72 offen sc1
    buffer_load_dwordx4 v[20:23], v1, s[40:43], s72 offen offset:1024 sc1
    s_waitcnt vmcnt(0)
L_chkm2:
    v_max3_u32 v24, v16, v17, v18
    v_max3_u32 v25, v19, v20, v21
    v_max3_u32 v24, v24, v22, v23
    v_max_u32 v24, v24, v25
    v_cmp_eq_u32 vcc, -1, v24
    s_nop 1
    s_cbranch_vccz L_done13
    s_mov_b64 exec, vcc
    s_sub_u32 s11, s11, 1
    s_cbranch_scc1 L_done13
    s_branch L_poll13
L_done13:
    s_mov_b64 exec, s[0:1]
    v_pk_add_f32 v[16:17], v[16:17], v[20:21]
    v_pk_add_f32 v[18:19], v[18:19], v[22:23]
    s_nop 0
    v_permlane16_swap_b32 v16, v17
    v_permlane16_swap_b32 v18, v19
    v_add_f32 v16, v16, v17
    v_add_f32 v18, v18, v19
    s_nop 1
    v_permlane32_swap_b32 v16, v18
    v_add_f32 v16, v16, v18
    s_nop 1
    v_add_f32_dpp v16, v16, v16 quad_perm:[2,3,0,1] row_mask:0xf bank_mask:0xf
    s_nop 1
    v_add_f32_dpp v16, v16, v16 row_ror:4 row_mask:0xf bank_mask:0xf
    s_nop 1
    v_add_f32_dpp v16, v16, v16 row_ror:8 row_mask:0xf bank_mask:0xf
    v_cvt_pk_bf16_f32 v16, v16, v16
    v_and_b32 v16, 0xffff0000, v16
    v_mul_f32 v16, v16, v57
    v_cvt_pk_bf16_f32 v16, v16, v16
    v_and_b32 v16, 0xffff0000, v16
    v_add_f32 v16, v53, v16
    v_cvt_pk_bf16_f32 v16, v16, v16
    s_mov_b32 exec_lo, 0x00030003
    s_mov_b32 exec_hi, 0x00030003
    buffer_store_short v16, v59, s[64:67], s70 offen
    s_cmp_lg_u32 s2, 0
    s_cbranch_scc1 L_fin
    s_and_b64 exec, s[0:1], 1
    v_mov_b32 v19, s10
    buffer_store_dword v19, v61, s[40:43], 0 offen sc1
L_fin:
L_end:
    s_endpgm
.section .rodata,"a"
.p2align 6
.amdhsa_kernel recurrent_scan__gqa_block_cached__glu_gated_swiglu__decode_kernel
.amdhsa_next_free_vgpr 512
.amdhsa_next_free_sgpr 102
.amdhsa_accum_offset 256
.amdhsa_group_segment_fixed_size 0
.amdhsa_kernarg_size 96
.amdhsa_user_sgpr_count 2
.amdhsa_user_sgpr_kernarg_segment_ptr 1
.amdhsa_system_sgpr_workgroup_id_x 1
.end_amdhsa_kernel
```
